```python
import torch

def _softmax(x, axis=-1):
    return torch.softmax(x, dim=axis)
def _gelu(x):
    return torch.nn.functional.gelu(x, approximate="tanh")
def _silu(x):
    return torch.nn.functional.silu(x)
def _sigmoid(x):
    return torch.sigmoid(x)
def _layernorm(x, axis=-1, eps=1e-5):
    m = x.mean(dim=axis, keepdim=True)
    v = x.var(dim=axis, keepdim=True, unbiased=False)
    return (x - m) / torch.sqrt(v + eps)
def _scatter_add(tgt, idx, src, axis=0):
    return tgt.clone().index_add_(axis, idx, src)
def _segment_sum(src, seg, n):
    out = torch.zeros((n,) + src.shape[1:], dtype=src.dtype)
    return out.index_add_(0, seg, src)
def _pad(x, pw):
    flat = tuple(v for pair in reversed(pw) for v in pair)
    return torch.nn.functional.pad(x, flat)

kernel_name = 'sequential_preLN__mha_block_cached__glu_gated_geglu__decode'

def setup_inputs():

    _w = (lambda a: (lambda t: t.to(torch.bfloat16) if t.is_floating_point() else t)(torch.as_tensor(a)))
    def _A_setup():
        B, Sq, D = 2, 1, 576
        H, Sk, Dh = 32, 8192, 128
        return {
            "x": _w((lambda *s: torch.randn(*s, dtype=torch.bfloat16) * 0.05)(B, Sq, D)),
            "k_cache": _w((lambda *s: torch.randn(*s, dtype=torch.bfloat16) * 1.6)(B, H, Sk, Dh)),
            "v_cache": _w((lambda *s: torch.randn(*s, dtype=torch.bfloat16) * 0.8)(B, H, Sk, Dh)),
            "wq": _w((lambda *s: torch.randn(*s, dtype=torch.bfloat16) * 1.6)(D, H * Dh) * (D ** -0.5)),
            "wo": _w((lambda *s: torch.randn(*s, dtype=torch.bfloat16) * 0.8)(H * Dh, D) * ((H * Dh) ** -0.5)),
        }
    _A_in = _A_setup()

    def _B_setup():
        B, S, Dm, Df = 2, 1, 576, 4608
        return {
            "x": _w((lambda *s: torch.randn(*s, dtype=torch.bfloat16) * 0.05)(B, S, Dm)),
            "w_gate": _w((lambda *s: torch.randn(*s, dtype=torch.bfloat16) * 0.8)(Dm, Df) * (Dm ** -0.5)),
            "w_up": _w((lambda *s: torch.randn(*s, dtype=torch.bfloat16) * 0.8)(Dm, Df) * (Dm ** -0.5)),
            "w_down": _w((lambda *s: torch.randn(*s, dtype=torch.bfloat16) * 0.8)(Df, Dm) * (Df ** -0.5)),
        }
    _B_in = _B_setup()

    return {
        "A_x": _A_in["x"],
        "A_k_cache": _A_in["k_cache"],
        "A_v_cache": _A_in["v_cache"],
        "A_wq": _A_in["wq"],
        "A_wo": _A_in["wo"],
        "B_x": _B_in["x"],
        "B_w_gate": _B_in["w_gate"],
        "B_w_up": _B_in["w_up"],
        "B_w_down": _B_in["w_down"],
    }

def reference(A_x, A_k_cache, A_v_cache, A_wq, A_wo, B_x, B_w_gate, B_w_up, B_w_down):
    def _A_ref(x, k_cache, v_cache, wq, wo):
        B, Sq, D = x.shape
        H, Dh = 32, 128
        q = (lambda x, *d: x.permute(*d))((x @ wq).reshape(B, Sq, H, Dh), 0, 2, 1, 3)
        scores = torch.einsum("bhqd,bhkd->bhqk", q, k_cache) * (Dh ** -0.5)
        p = _softmax(scores, axis=-1)
        o = torch.einsum("bhqk,bhkd->bhqd", p, v_cache)
        return (lambda x, *d: x.permute(*d))(o, 0, 2, 1, 3).reshape(B, Sq, H * Dh) @ wo

    def _B_ref(x, w_gate, w_up, w_down):
        g = torch.einsum("bsd,df->bsf", x, w_gate)
        u = torch.einsum("bsd,df->bsf", x, w_up)
        h = _gelu(g) * u
        return torch.einsum("bsf,fd->bsd", h, w_down)

    x = A_x
    h = x + _A_ref(_layernorm(x, axis=-1), A_k_cache, A_v_cache, A_wq, A_wo)
    h2 = h + _B_ref(_layernorm(h, axis=-1), B_w_gate, B_w_up, B_w_down)
    return h2
```

```asm
; @launch grid=(256,1,1) block=(512,1,1) lds=160832
.amdgcn_target "amdgcn-amd-amdhsa--gfx950"
.text
.globl sequential_preLN__mha_block_cached__glu_gated_geglu__decode_kernel
.p2align 12
.p2align 8
.type sequential_preLN__mha_block_cached__glu_gated_geglu__decode_kernel,@function
sequential_preLN__mha_block_cached__glu_gated_geglu__decode_kernel:
  s_cmp_ge_u32 s2, 256
  s_cbranch_scc1 L_end
  s_load_dwordx16 s[16:31], s[0:1], 0
  s_load_dwordx8 s[32:39], s[0:1], 64
  v_and_b32 v1, 63, v0
  v_lshrrev_b32 v2, 6, v0
  s_lshr_b32 s8, s2, 3
  v_readfirstlane_b32 s3, v2
  s_and_b32 s9, s2, 7
  s_and_b32 s4, s2, 31
  s_lshr_b32 s10, s2, 5
  s_and_b32 s5, s10, 3
  s_lshr_b32 s6, s10, 2
  s_lshl_b32 s7, s6, 5
  s_add_u32 s7, s7, s4
  v_lshrrev_b32 v10, 4, v1
  v_and_b32 v11, 15, v1
  s_cmp_ge_u32 s3, 4
  s_cbranch_scc1 L_aux
  s_setprio 1
  s_lshl_b32 s10, s3, 12
  s_lshl_b32 s12, s5, 15
  s_add_u32 s10, s10, s12
  v_bfe_u32 v4, v1, 2, 2
  v_lshlrev_b32 v5, 8, v4
  v_lshlrev_b32 v6, 6, v10
  v_and_b32 v7, 3, v1
  v_lshlrev_b32 v7, 4, v7
  v_add3_u32 v2, v5, v6, v7
  v_add_u32 v2, s10, v2
  v_lshlrev_b32 v5, 8, v10
  v_lshl_add_u32 v3, v11, 4, v5
  v_add_u32 v3, s10, v3
  s_lshl_b32 s10, s7, 21
  s_waitcnt lgkmcnt(0)
  s_add_u32 s12, s18, s10
  s_addc_u32 s13, s19, 0
  s_mov_b32 s40, s12
  s_and_b32 s41, s13, 0xffff
  s_mov_b32 s42, 2097152
  s_mov_b32 s43, 0x20000
  s_add_u32 s12, s20, s10
  s_addc_u32 s13, s21, 0
  s_mov_b32 s44, s12
  s_and_b32 s45, s13, 0xffff
  s_mov_b32 s46, 2097152
  s_mov_b32 s47, 0x20000
  s_mul_i32 s13, s3, 28672
  s_add_u32 m0, s13, 0
  s_nop 0
  buffer_load_dwordx4 v2, s[40:43], 0 offen offset:0 nt lds
  buffer_load_dwordx4 v2, s[40:43], 0 offen offset:1024 nt lds
  buffer_load_dwordx4 v2, s[40:43], 0 offen offset:2048 nt lds
  buffer_load_dwordx4 v2, s[40:43], 0 offen offset:3072 nt lds
  s_mov_b32 s14, 16384
  s_add_u32 m0, s13, 4096
  s_nop 0
  buffer_load_dwordx4 v2, s[40:43], s14 offen offset:0 nt lds
  buffer_load_dwordx4 v2, s[40:43], s14 offen offset:1024 nt lds
  s_mov_b32 s56, s38
  s_and_b32 s57, s39, 0xffff
  s_mov_b32 s58, 4194304
  s_mov_b32 s59, 0x20000
  v_and_b32 v4, 1, v11
  v_lshlrev_b32 v4, 4, v4
  v_mov_b32 v5, 0xffff
  v_lshlrev_b32 v4, v4, v5
  v_lshrrev_b32 v5, 1, v11
  v_cmp_eq_u32 vcc, 0, v5
  s_nop 1
  v_cndmask_b32 v32, 0, v4, vcc
  v_cmp_eq_u32 vcc, 1, v5
  s_nop 1
  v_cndmask_b32 v33, 0, v4, vcc
  v_cmp_eq_u32 vcc, 2, v5
  s_nop 1
  v_cndmask_b32 v34, 0, v4, vcc
  v_cmp_eq_u32 vcc, 3, v5
  s_nop 1
  v_cndmask_b32 v35, 0, v4, vcc
  v_mov_b32 v12, 0xff800000
  s_mul_i32 s15, s9, 18
  s_add_u32 s15, s15, s8
  v_lshlrev_b32 v8, 4, v1
  v_add_u32 v8, s13, v8
  v_and_b32 v9, 3, v1
  v_lshl_add_u32 v9, v10, 2, v9
  v_lshlrev_b32 v9, 4, v9
  v_add_u32 v9, 151552, v9
  v_mov_b32 v14, 160768
  v_mov_b32 v63, 160768
  v_cmp_eq_u32 vcc, 0, v1
  s_nop 1
  v_cndmask_b32 v0, 0, 1, vcc
L_s1:
  s_barrier
  s_waitcnt vmcnt(5)
  buffer_load_dwordx4 v2, s[40:43], s14 offen offset:2048 nt lds
  s_waitcnt vmcnt(5)
  buffer_load_dwordx4 v2, s[40:43], s14 offen offset:3072 nt lds
  s_waitcnt vmcnt(5)
  s_mov_b32 s14, 131072
  s_add_u32 m0, s13, 8192
  s_nop 0
  buffer_load_dwordx4 v2, s[40:43], s14 offen offset:0 nt lds
  s_waitcnt vmcnt(5)
  buffer_load_dwordx4 v2, s[40:43], s14 offen offset:1024 nt lds
  s_waitcnt vmcnt(5)
  buffer_load_dwordx4 v2, s[40:43], s14 offen offset:2048 nt lds
  s_waitcnt vmcnt(5)
  buffer_load_dwordx4 v2, s[40:43], s14 offen offset:3072 nt lds
  s_waitcnt vmcnt(5)
  s_mov_b32 s14, 147456
  s_add_u32 m0, s13, 12288
  s_nop 0
  buffer_load_dwordx4 v2, s[40:43], s14 offen offset:0 nt lds
  s_waitcnt vmcnt(5)
  buffer_load_dwordx4 v2, s[40:43], s14 offen offset:1024 nt lds
  s_waitcnt vmcnt(5)
  buffer_load_dwordx4 v2, s[40:43], s14 offen offset:2048 nt lds
  s_waitcnt vmcnt(5)
  buffer_load_dwordx4 v2, s[40:43], s14 offen offset:3072 nt lds
  s_waitcnt vmcnt(5)
  s_mov_b32 s14, 262144
  s_add_u32 m0, s13, 16384
  s_nop 0
  buffer_load_dwordx4 v2, s[40:43], s14 offen offset:0 nt lds
  s_waitcnt vmcnt(5)
  buffer_load_dwordx4 v2, s[40:43], s14 offen offset:1024 nt lds
  s_waitcnt vmcnt(5)
  buffer_load_dwordx4 v2, s[40:43], s14 offen offset:2048 nt lds
  s_waitcnt vmcnt(5)
  buffer_load_dwordx4 v2, s[40:43], s14 offen offset:3072 nt lds
  s_waitcnt vmcnt(5)
  s_mov_b32 s14, 278528
  s_add_u32 m0, s13, 20480
  s_nop 0
  buffer_load_dwordx4 v2, s[40:43], s14 offen offset:0 nt lds
  s_waitcnt vmcnt(5)
  buffer_load_dwordx4 v2, s[40:43], s14 offen offset:1024 nt lds
  s_waitcnt vmcnt(5)
  buffer_load_dwordx4 v2, s[40:43], s14 offen offset:2048 nt lds
  s_waitcnt vmcnt(5)
  buffer_load_dwordx4 v2, s[40:43], s14 offen offset:3072 nt lds
  s_waitcnt vmcnt(5)
  s_mov_b32 s14, 393216
  s_add_u32 m0, s13, 24576
  s_nop 0
  buffer_load_dwordx4 v2, s[40:43], s14 offen offset:0 nt lds
  s_waitcnt vmcnt(5)
  buffer_load_dwordx4 v2, s[40:43], s14 offen offset:1024 nt lds
  s_waitcnt vmcnt(5)
  buffer_load_dwordx4 v2, s[40:43], s14 offen offset:2048 nt lds
  s_waitcnt vmcnt(5)
  buffer_load_dwordx4 v2, s[40:43], s14 offen offset:3072 nt lds
  s_waitcnt vmcnt(5)
  s_mov_b32 s14, 409600
  buffer_load_dwordx4 v[96:99], v2, s[40:43], s14 offen offset:0 nt
  s_waitcnt vmcnt(5)
  buffer_load_dwordx4 v[100:103], v2, s[40:43], s14 offen offset:1024 nt
  s_waitcnt vmcnt(5)
  buffer_load_dwordx4 v[104:107], v2, s[40:43], s14 offen offset:2048 nt
  s_waitcnt vmcnt(5)
  buffer_load_dwordx4 v[108:111], v2, s[40:43], s14 offen offset:3072 nt
  s_waitcnt vmcnt(5)
  s_mov_b32 s14, 524288
  buffer_load_dwordx4 v[112:115], v2, s[40:43], s14 offen offset:0 nt
  s_waitcnt vmcnt(5)
  buffer_load_dwordx4 v[116:119], v2, s[40:43], s14 offen offset:1024 nt
  s_waitcnt vmcnt(5)
  buffer_load_dwordx4 v[120:123], v2, s[40:43], s14 offen offset:2048 nt
  s_waitcnt vmcnt(5)
  buffer_load_dwordx4 v[124:127], v2, s[40:43], s14 offen offset:3072 nt
  s_waitcnt vmcnt(5)
  s_mov_b32 s14, 540672
  buffer_load_dwordx4 v[128:131], v2, s[40:43], s14 offen offset:0 nt
  s_waitcnt vmcnt(5)
  buffer_load_dwordx4 v[132:135], v2, s[40:43], s14 offen offset:1024 nt
  s_waitcnt vmcnt(5)
  buffer_load_dwordx4 v[136:139], v2, s[40:43], s14 offen offset:2048 nt
  s_waitcnt vmcnt(5)
  buffer_load_dwordx4 v[140:143], v2, s[40:43], s14 offen offset:3072 nt
  s_waitcnt vmcnt(5)
  s_mov_b32 s14, 655360
  buffer_load_dwordx4 v[144:147], v2, s[40:43], s14 offen offset:0 nt
  s_waitcnt vmcnt(5)
  buffer_load_dwordx4 v[148:151], v2, s[40:43], s14 offen offset:1024 nt
  s_waitcnt vmcnt(5)
  buffer_load_dwordx4 v[152:155], v2, s[40:43], s14 offen offset:2048 nt
  s_waitcnt vmcnt(5)
  buffer_load_dwordx4 v[156:159], v2, s[40:43], s14 offen offset:3072 nt
  s_waitcnt vmcnt(5)
  s_mov_b32 s14, 671744
  buffer_load_dwordx4 v[160:163], v2, s[40:43], s14 offen offset:0 nt
  s_waitcnt vmcnt(5)
  buffer_load_dwordx4 v[164:167], v2, s[40:43], s14 offen offset:1024 nt
  s_waitcnt vmcnt(5)
  buffer_load_dwordx4 v[168:171], v2, s[40:43], s14 offen offset:2048 nt
  s_waitcnt vmcnt(5)
  buffer_load_dwordx4 v[172:175], v2, s[40:43], s14 offen offset:3072 nt
  s_waitcnt vmcnt(5)
  s_mov_b32 s14, 786432
  buffer_load_dwordx4 v[176:179], v2, s[40:43], s14 offen offset:0 nt
  s_waitcnt vmcnt(5)
  buffer_load_dwordx4 v[180:183], v2, s[40:43], s14 offen offset:1024 nt
  s_waitcnt vmcnt(5)
  buffer_load_dwordx4 v[184:187], v2, s[40:43], s14 offen offset:2048 nt
  s_waitcnt vmcnt(5)
  buffer_load_dwordx4 v[188:191], v2, s[40:43], s14 offen offset:3072 nt
  s_waitcnt vmcnt(5)
  s_mov_b32 s14, 802816
  buffer_load_dwordx4 v[192:195], v2, s[40:43], s14 offen offset:0 nt
  s_waitcnt vmcnt(5)
  buffer_load_dwordx4 v[196:199], v2, s[40:43], s14 offen offset:1024 nt
  s_waitcnt vmcnt(5)
  buffer_load_dwordx4 v[200:203], v2, s[40:43], s14 offen offset:2048 nt
  s_waitcnt vmcnt(5)
  buffer_load_dwordx4 v[204:207], v2, s[40:43], s14 offen offset:3072 nt
  ds_read_b32 v15, v14
  ds_read_b128 v[56:59], v9
  s_waitcnt vmcnt(5)
  s_mov_b32 s14, 917504
  buffer_load_dwordx4 v[208:211], v2, s[40:43], s14 offen offset:0 nt
  s_waitcnt vmcnt(5)
  buffer_load_dwordx4 v[212:215], v2, s[40:43], s14 offen offset:1024 nt
  s_mov_b32 s11, 0
L_qspin_2:
  s_waitcnt lgkmcnt(0)
  v_cmp_ne_u32 vcc, 0, v15
  s_cbranch_vccnz L_qok_1
  ds_read_b32 v15, v14
  ds_read_b128 v[56:59], v9
  s_add_u32 s11, s11, 1
  s_cmp_lt_u32 s11, 262144
  s_cbranch_scc1 L_qspin_2
  s_waitcnt lgkmcnt(0)
L_qok_1:
  s_lshr_b32 s10, s8, 3
  s_lshl_b32 s10, s10, 2
  s_and_b32 s101, s8, 3
  s_add_u32 s10, s10, s101
  s_cmp_lt_u32 s10, 10
  s_cselect_b32 s101, 1, 0
  v_lshrrev_b32 v4, 2, v1
  v_and_b32 v4, 3, v4
  v_cmp_eq_u32 vcc, 0, v4
  s_nop 1
  v_cndmask_b32 v16, 0, v56, vcc
  v_cndmask_b32 v17, 0, v57, vcc
  v_cndmask_b32 v18, 0, v58, vcc
  v_cndmask_b32 v19, 0, v59, vcc
  v_cmp_eq_u32 vcc, 1, v4
  s_nop 1
  v_cndmask_b32 v20, 0, v56, vcc
  v_cndmask_b32 v21, 0, v57, vcc
  v_cndmask_b32 v22, 0, v58, vcc
  v_cndmask_b32 v23, 0, v59, vcc
  v_cmp_eq_u32 vcc, 2, v4
  s_nop 1
  v_cndmask_b32 v24, 0, v56, vcc
  v_cndmask_b32 v25, 0, v57, vcc
  v_cndmask_b32 v26, 0, v58, vcc
  v_cndmask_b32 v27, 0, v59, vcc
  v_cmp_eq_u32 vcc, 3, v4
  s_nop 1
  v_cndmask_b32 v28, 0, v56, vcc
  v_cndmask_b32 v29, 0, v57, vcc
  v_cndmask_b32 v30, 0, v58, vcc
  v_cndmask_b32 v31, 0, v59, vcc
  s_waitcnt vmcnt(5)
  buffer_load_dwordx4 v[216:219], v2, s[40:43], s14 offen offset:2048 nt
  v_mfma_f32_16x16x32_bf16 v[36:39], v[96:99], v[16:19], 0
  v_mfma_f32_16x16x32_bf16 v[36:39], v[100:103], v[20:23], v[36:39]
  v_mfma_f32_16x16x32_bf16 v[36:39], v[104:107], v[24:27], v[36:39]
  v_mfma_f32_16x16x32_bf16 v[36:39], v[108:111], v[28:31], v[36:39]
  ds_read_b128 v[224:227], v8 offset:0
  ds_read_b128 v[228:231], v8 offset:1024
  ds_read_b128 v[232:235], v8 offset:2048
  ds_read_b128 v[236:239], v8 offset:3072
  s_waitcnt vmcnt(5)
  buffer_load_dwordx4 v[220:223], v2, s[40:43], s14 offen offset:3072 nt
  v_mfma_f32_16x16x32_bf16 v[40:43], v[112:115], v[16:19], 0
  v_mfma_f32_16x16x32_bf16 v[40:43], v[116:119], v[20:23], v[40:43]
  v_mfma_f32_16x16x32_bf16 v[40:43], v[120:123], v[24:27], v[40:43]
  v_mfma_f32_16x16x32_bf16 v[40:43], v[124:127], v[28:31], v[40:43]
  v_mov_b32_dpp v4, v36 quad_perm:[0,0,0,0] row_mask:0xf bank_mask:0xf
  v_mov_b32_dpp v5, v38 quad_perm:[2,2,2,2] row_mask:0xf bank_mask:0xf
  s_nop 0
  v_add_f32_dpp v4, v37, v4 quad_perm:[1,1,1,1] row_mask:0xf bank_mask:0xf
  v_add_f32_dpp v5, v39, v5 quad_perm:[3,3,3,3] row_mask:0xf bank_mask:0xf
  v_add_f32 v4, v4, v5
  v_cvt_pk_bf16_f32 v4, v4, v4
  v_and_b32 v4, 0xffff0000, v4
  v_mul_f32 v4, 0x3db504f3, v4
  v_cvt_pk_bf16_f32 v71, v4, v4
  v_and_b32 v71, 0xffff0000, v71
  v_max_f32 v12, v12, v71
  s_waitcnt vmcnt(5)
  s_mov_b32 s14, 933888
  buffer_load_dwordx4 v[240:243], v2, s[40:43], s14 offen offset:0 nt
  v_mfma_f32_16x16x32_bf16 v[36:39], v[128:131], v[16:19], 0
  v_mfma_f32_16x16x32_bf16 v[36:39], v[132:135], v[20:23], v[36:39]
  v_mfma_f32_16x16x32_bf16 v[36:39], v[136:139], v[24:27], v[36:39]
  v_mfma_f32_16x16x32_bf16 v[36:39], v[140:143], v[28:31], v[36:39]
  v_mov_b32_dpp v4, v40 quad_perm:[0,0,0,0] row_mask:0xf bank_mask:0xf
  v_mov_b32_dpp v5, v42 quad_perm:[2,2,2,2] row_mask:0xf bank_mask:0xf
  s_nop 0
  v_add_f32_dpp v4, v41, v4 quad_perm:[1,1,1,1] row_mask:0xf bank_mask:0xf
  v_add_f32_dpp v5, v43, v5 quad_perm:[3,3,3,3] row_mask:0xf bank_mask:0xf
  v_add_f32 v4, v4, v5
  v_cvt_pk_bf16_f32 v4, v4, v4
  v_and_b32 v4, 0xffff0000, v4
  v_mul_f32 v4, 0x3db504f3, v4
  v_cvt_pk_bf16_f32 v72, v4, v4
  v_and_b32 v72, 0xffff0000, v72
  v_max_f32 v12, v12, v72
  s_waitcnt vmcnt(5)
  buffer_load_dwordx4 v[244:247], v2, s[40:43], s14 offen offset:1024 nt
  v_mfma_f32_16x16x32_bf16 v[40:43], v[144:147], v[16:19], 0
  v_mfma_f32_16x16x32_bf16 v[40:43], v[148:151], v[20:23], v[40:43]
  v_mfma_f32_16x16x32_bf16 v[40:43], v[152:155], v[24:27], v[40:43]
  v_mfma_f32_16x16x32_bf16 v[40:43], v[156:159], v[28:31], v[40:43]
  v_mov_b32_dpp v4, v36 quad_perm:[0,0,0,0] row_mask:0xf bank_mask:0xf
  v_mov_b32_dpp v5, v38 quad_perm:[2,2,2,2] row_mask:0xf bank_mask:0xf
  s_nop 0
  v_add_f32_dpp v4, v37, v4 quad_perm:[1,1,1,1] row_mask:0xf bank_mask:0xf
  v_add_f32_dpp v5, v39, v5 quad_perm:[3,3,3,3] row_mask:0xf bank_mask:0xf
  v_add_f32 v4, v4, v5
  v_cvt_pk_bf16_f32 v4, v4, v4
  v_and_b32 v4, 0xffff0000, v4
  v_mul_f32 v4, 0x3db504f3, v4
  v_cvt_pk_bf16_f32 v73, v4, v4
  v_and_b32 v73, 0xffff0000, v73
  v_max_f32 v12, v12, v73
  s_waitcnt vmcnt(5)
  buffer_load_dwordx4 v[248:251], v2, s[40:43], s14 offen offset:2048 nt
  v_mfma_f32_16x16x32_bf16 v[36:39], v[160:163], v[16:19], 0
  v_mfma_f32_16x16x32_bf16 v[36:39], v[164:167], v[20:23], v[36:39]
  v_mfma_f32_16x16x32_bf16 v[36:39], v[168:171], v[24:27], v[36:39]
  v_mfma_f32_16x16x32_bf16 v[36:39], v[172:175], v[28:31], v[36:39]
  v_mov_b32_dpp v4, v40 quad_perm:[0,0,0,0] row_mask:0xf bank_mask:0xf
  v_mov_b32_dpp v5, v42 quad_perm:[2,2,2,2] row_mask:0xf bank_mask:0xf
  s_nop 0
  v_add_f32_dpp v4, v41, v4 quad_perm:[1,1,1,1] row_mask:0xf bank_mask:0xf
  v_add_f32_dpp v5, v43, v5 quad_perm:[3,3,3,3] row_mask:0xf bank_mask:0xf
  v_add_f32 v4, v4, v5
  v_cvt_pk_bf16_f32 v4, v4, v4
  v_and_b32 v4, 0xffff0000, v4
  v_mul_f32 v4, 0x3db504f3, v4
  v_cvt_pk_bf16_f32 v74, v4, v4
  v_and_b32 v74, 0xffff0000, v74
  v_max_f32 v12, v12, v74
  s_waitcnt vmcnt(5)
  buffer_load_dwordx4 v[252:255], v2, s[40:43], s14 offen offset:3072 nt
  v_mfma_f32_16x16x32_bf16 v[40:43], v[176:179], v[16:19], 0
  v_mfma_f32_16x16x32_bf16 v[40:43], v[180:183], v[20:23], v[40:43]
  v_mfma_f32_16x16x32_bf16 v[40:43], v[184:187], v[24:27], v[40:43]
  v_mfma_f32_16x16x32_bf16 v[40:43], v[188:191], v[28:31], v[40:43]
  v_mov_b32_dpp v4, v36 quad_perm:[0,0,0,0] row_mask:0xf bank_mask:0xf
  v_mov_b32_dpp v5, v38 quad_perm:[2,2,2,2] row_mask:0xf bank_mask:0xf
  s_nop 0
  v_add_f32_dpp v4, v37, v4 quad_perm:[1,1,1,1] row_mask:0xf bank_mask:0xf
  v_add_f32_dpp v5, v39, v5 quad_perm:[3,3,3,3] row_mask:0xf bank_mask:0xf
  v_add_f32 v4, v4, v5
  v_cvt_pk_bf16_f32 v4, v4, v4
  v_and_b32 v4, 0xffff0000, v4
  v_mul_f32 v4, 0x3db504f3, v4
  v_cvt_pk_bf16_f32 v75, v4, v4
  v_and_b32 v75, 0xffff0000, v75
  v_max_f32 v12, v12, v75
  s_waitcnt vmcnt(5)
  s_mov_b32 s14, 1048576
  buffer_load_dwordx4 v[96:99], v2, s[40:43], s14 offen offset:0 nt
  v_mfma_f32_16x16x32_bf16 v[36:39], v[192:195], v[16:19], 0
  v_mfma_f32_16x16x32_bf16 v[36:39], v[196:199], v[20:23], v[36:39]
  v_mfma_f32_16x16x32_bf16 v[36:39], v[200:203], v[24:27], v[36:39]
  v_mfma_f32_16x16x32_bf16 v[36:39], v[204:207], v[28:31], v[36:39]
  v_mov_b32_dpp v4, v40 quad_perm:[0,0,0,0] row_mask:0xf bank_mask:0xf
  v_mov_b32_dpp v5, v42 quad_perm:[2,2,2,2] row_mask:0xf bank_mask:0xf
  s_nop 0
  v_add_f32_dpp v4, v41, v4 quad_perm:[1,1,1,1] row_mask:0xf bank_mask:0xf
  v_add_f32_dpp v5, v43, v5 quad_perm:[3,3,3,3] row_mask:0xf bank_mask:0xf
  v_add_f32 v4, v4, v5
  v_cvt_pk_bf16_f32 v4, v4, v4
  v_and_b32 v4, 0xffff0000, v4
  v_mul_f32 v4, 0x3db504f3, v4
  v_cvt_pk_bf16_f32 v76, v4, v4
  v_and_b32 v76, 0xffff0000, v76
  v_max_f32 v12, v12, v76
  s_waitcnt vmcnt(5)
  buffer_load_dwordx4 v[100:103], v2, s[40:43], s14 offen offset:1024 nt
  v_mfma_f32_16x16x32_bf16 v[40:43], v[208:211], v[16:19], 0
  v_mfma_f32_16x16x32_bf16 v[40:43], v[212:215], v[20:23], v[40:43]
  v_mfma_f32_16x16x32_bf16 v[40:43], v[216:219], v[24:27], v[40:43]
  v_mfma_f32_16x16x32_bf16 v[40:43], v[220:223], v[28:31], v[40:43]
  v_mov_b32_dpp v4, v36 quad_perm:[0,0,0,0] row_mask:0xf bank_mask:0xf
  v_mov_b32_dpp v5, v38 quad_perm:[2,2,2,2] row_mask:0xf bank_mask:0xf
  s_nop 0
  v_add_f32_dpp v4, v37, v4 quad_perm:[1,1,1,1] row_mask:0xf bank_mask:0xf
  v_add_f32_dpp v5, v39, v5 quad_perm:[3,3,3,3] row_mask:0xf bank_mask:0xf
  v_add_f32 v4, v4, v5
  v_cvt_pk_bf16_f32 v4, v4, v4
  v_and_b32 v4, 0xffff0000, v4
  v_mul_f32 v4, 0x3db504f3, v4
  v_cvt_pk_bf16_f32 v77, v4, v4
  v_and_b32 v77, 0xffff0000, v77
  v_max_f32 v12, v12, v77
  s_waitcnt vmcnt(5)
  buffer_load_dwordx4 v[104:107], v2, s[40:43], s14 offen offset:2048 nt
  s_waitcnt lgkmcnt(0)
  v_mfma_f32_16x16x32_bf16 v[36:39], v[224:227], v[16:19], 0
  v_mfma_f32_16x16x32_bf16 v[36:39], v[228:231], v[20:23], v[36:39]
  v_mfma_f32_16x16x32_bf16 v[36:39], v[232:235], v[24:27], v[36:39]
  v_mfma_f32_16x16x32_bf16 v[36:39], v[236:239], v[28:31], v[36:39]
  v_mov_b32_dpp v4, v40 quad_perm:[0,0,0,0] row_mask:0xf bank_mask:0xf
  v_mov_b32_dpp v5, v42 quad_perm:[2,2,2,2] row_mask:0xf bank_mask:0xf
  s_nop 0
  v_add_f32_dpp v4, v41, v4 quad_perm:[1,1,1,1] row_mask:0xf bank_mask:0xf
  v_add_f32_dpp v5, v43, v5 quad_perm:[3,3,3,3] row_mask:0xf bank_mask:0xf
  v_add_f32 v4, v4, v5
  v_cvt_pk_bf16_f32 v4, v4, v4
  v_and_b32 v4, 0xffff0000, v4
  v_mul_f32 v4, 0x3db504f3, v4
  v_cvt_pk_bf16_f32 v78, v4, v4
  v_and_b32 v78, 0xffff0000, v78
  v_max_f32 v12, v12, v78
  ds_read_b128 v[112:115], v8 offset:4096
  ds_read_b128 v[116:119], v8 offset:5120
  ds_read_b128 v[120:123], v8 offset:6144
  ds_read_b128 v[124:127], v8 offset:7168
  s_waitcnt vmcnt(5)
  buffer_load_dwordx4 v[108:111], v2, s[40:43], s14 offen offset:3072 nt
  s_waitcnt lgkmcnt(0)
  v_mfma_f32_16x16x32_bf16 v[40:43], v[112:115], v[16:19], 0
  v_mfma_f32_16x16x32_bf16 v[40:43], v[116:119], v[20:23], v[40:43]
  v_mfma_f32_16x16x32_bf16 v[40:43], v[120:123], v[24:27], v[40:43]
  v_mfma_f32_16x16x32_bf16 v[40:43], v[124:127], v[28:31], v[40:43]
  v_mov_b32_dpp v4, v36 quad_perm:[0,0,0,0] row_mask:0xf bank_mask:0xf
  v_mov_b32_dpp v5, v38 quad_perm:[2,2,2,2] row_mask:0xf bank_mask:0xf
  s_nop 0
  v_add_f32_dpp v4, v37, v4 quad_perm:[1,1,1,1] row_mask:0xf bank_mask:0xf
  v_add_f32_dpp v5, v39, v5 quad_perm:[3,3,3,3] row_mask:0xf bank_mask:0xf
  v_add_f32 v4, v4, v5
  v_cvt_pk_bf16_f32 v4, v4, v4
  v_and_b32 v4, 0xffff0000, v4
  v_mul_f32 v4, 0x3db504f3, v4
  v_cvt_pk_bf16_f32 v64, v4, v4
  v_and_b32 v64, 0xffff0000, v64
  v_max_f32 v12, v12, v64
  ds_read_b128 v[128:131], v8 offset:8192
  ds_read_b128 v[132:135], v8 offset:9216
  ds_read_b128 v[136:139], v8 offset:10240
  ds_read_b128 v[140:143], v8 offset:11264
  s_waitcnt vmcnt(5)
  s_mov_b32 s14, 1064960
  buffer_load_dwordx4 v[144:147], v2, s[40:43], s14 offen offset:0 nt
  s_waitcnt lgkmcnt(0)
  v_mfma_f32_16x16x32_bf16 v[36:39], v[128:131], v[16:19], 0
  v_mfma_f32_16x16x32_bf16 v[36:39], v[132:135], v[20:23], v[36:39]
  v_mfma_f32_16x16x32_bf16 v[36:39], v[136:139], v[24:27], v[36:39]
  v_mfma_f32_16x16x32_bf16 v[36:39], v[140:143], v[28:31], v[36:39]
  v_mov_b32_dpp v4, v40 quad_perm:[0,0,0,0] row_mask:0xf bank_mask:0xf
  v_mov_b32_dpp v5, v42 quad_perm:[2,2,2,2] row_mask:0xf bank_mask:0xf
  s_nop 0
  v_add_f32_dpp v4, v41, v4 quad_perm:[1,1,1,1] row_mask:0xf bank_mask:0xf
  v_add_f32_dpp v5, v43, v5 quad_perm:[3,3,3,3] row_mask:0xf bank_mask:0xf
  v_add_f32 v4, v4, v5
  v_cvt_pk_bf16_f32 v4, v4, v4
  v_and_b32 v4, 0xffff0000, v4
  v_mul_f32 v4, 0x3db504f3, v4
  v_cvt_pk_bf16_f32 v65, v4, v4
  v_and_b32 v65, 0xffff0000, v65
  v_max_f32 v12, v12, v65
  ds_read_b128 v[160:163], v8 offset:12288
  ds_read_b128 v[164:167], v8 offset:13312
  ds_read_b128 v[168:171], v8 offset:14336
  ds_read_b128 v[172:175], v8 offset:15360
  s_waitcnt vmcnt(5)
  buffer_load_dwordx4 v[148:151], v2, s[40:43], s14 offen offset:1024 nt
  v_mfma_f32_16x16x32_bf16 v[40:43], v[240:243], v[16:19], 0
  v_mfma_f32_16x16x32_bf16 v[40:43], v[244:247], v[20:23], v[40:43]
  v_mfma_f32_16x16x32_bf16 v[40:43], v[248:251], v[24:27], v[40:43]
  v_mfma_f32_16x16x32_bf16 v[40:43], v[252:255], v[28:31], v[40:43]
  v_mov_b32_dpp v4, v36 quad_perm:[0,0,0,0] row_mask:0xf bank_mask:0xf
  v_mov_b32_dpp v5, v38 quad_perm:[2,2,2,2] row_mask:0xf bank_mask:0xf
  s_nop 0
  v_add_f32_dpp v4, v37, v4 quad_perm:[1,1,1,1] row_mask:0xf bank_mask:0xf
  v_add_f32_dpp v5, v39, v5 quad_perm:[3,3,3,3] row_mask:0xf bank_mask:0xf
  v_add_f32 v4, v4, v5
  v_cvt_pk_bf16_f32 v4, v4, v4
  v_and_b32 v4, 0xffff0000, v4
  v_mul_f32 v4, 0x3db504f3, v4
  v_cvt_pk_bf16_f32 v66, v4, v4
  v_and_b32 v66, 0xffff0000, v66
  v_max_f32 v12, v12, v66
  s_waitcnt vmcnt(5)
  buffer_load_dwordx4 v[152:155], v2, s[40:43], s14 offen offset:2048 nt
  s_waitcnt lgkmcnt(0)
  v_mfma_f32_16x16x32_bf16 v[36:39], v[160:163], v[16:19], 0
  v_mfma_f32_16x16x32_bf16 v[36:39], v[164:167], v[20:23], v[36:39]
  v_mfma_f32_16x16x32_bf16 v[36:39], v[168:171], v[24:27], v[36:39]
  v_mfma_f32_16x16x32_bf16 v[36:39], v[172:175], v[28:31], v[36:39]
  v_mov_b32_dpp v4, v40 quad_perm:[0,0,0,0] row_mask:0xf bank_mask:0xf
  v_mov_b32_dpp v5, v42 quad_perm:[2,2,2,2] row_mask:0xf bank_mask:0xf
  s_nop 0
  v_add_f32_dpp v4, v41, v4 quad_perm:[1,1,1,1] row_mask:0xf bank_mask:0xf
  v_add_f32_dpp v5, v43, v5 quad_perm:[3,3,3,3] row_mask:0xf bank_mask:0xf
  v_add_f32 v4, v4, v5
  v_cvt_pk_bf16_f32 v4, v4, v4
  v_and_b32 v4, 0xffff0000, v4
  v_mul_f32 v4, 0x3db504f3, v4
  v_cvt_pk_bf16_f32 v79, v4, v4
  v_and_b32 v79, 0xffff0000, v79
  v_max_f32 v12, v12, v79
  ds_read_b128 v[176:179], v8 offset:16384
  ds_read_b128 v[180:183], v8 offset:17408
  ds_read_b128 v[184:187], v8 offset:18432
  ds_read_b128 v[188:191], v8 offset:19456
  s_waitcnt vmcnt(5)
  buffer_load_dwordx4 v[156:159], v2, s[40:43], s14 offen offset:3072 nt
  s_waitcnt lgkmcnt(0)
  v_mfma_f32_16x16x32_bf16 v[40:43], v[176:179], v[16:19], 0
  v_mfma_f32_16x16x32_bf16 v[40:43], v[180:183], v[20:23], v[40:43]
  v_mfma_f32_16x16x32_bf16 v[40:43], v[184:187], v[24:27], v[40:43]
  v_mfma_f32_16x16x32_bf16 v[40:43], v[188:191], v[28:31], v[40:43]
  v_mov_b32_dpp v4, v36 quad_perm:[0,0,0,0] row_mask:0xf bank_mask:0xf
  v_mov_b32_dpp v5, v38 quad_perm:[2,2,2,2] row_mask:0xf bank_mask:0xf
  s_nop 0
  v_add_f32_dpp v4, v37, v4 quad_perm:[1,1,1,1] row_mask:0xf bank_mask:0xf
  v_add_f32_dpp v5, v39, v5 quad_perm:[3,3,3,3] row_mask:0xf bank_mask:0xf
  v_add_f32 v4, v4, v5
  v_cvt_pk_bf16_f32 v4, v4, v4
  v_and_b32 v4, 0xffff0000, v4
  v_mul_f32 v4, 0x3db504f3, v4
  v_cvt_pk_bf16_f32 v67, v4, v4
  v_and_b32 v67, 0xffff0000, v67
  v_max_f32 v12, v12, v67
  ds_read_b128 v[192:195], v8 offset:20480
  ds_read_b128 v[196:199], v8 offset:21504
  ds_read_b128 v[200:203], v8 offset:22528
  ds_read_b128 v[204:207], v8 offset:23552
  s_waitcnt vmcnt(5)
  s_mov_b32 s14, 1179648
  buffer_load_dwordx4 v[208:211], v2, s[40:43], s14 offen offset:0 nt
  s_waitcnt lgkmcnt(0)
  v_mfma_f32_16x16x32_bf16 v[36:39], v[192:195], v[16:19], 0
  v_mfma_f32_16x16x32_bf16 v[36:39], v[196:199], v[20:23], v[36:39]
  v_mfma_f32_16x16x32_bf16 v[36:39], v[200:203], v[24:27], v[36:39]
  v_mfma_f32_16x16x32_bf16 v[36:39], v[204:207], v[28:31], v[36:39]
  v_mov_b32_dpp v4, v40 quad_perm:[0,0,0,0] row_mask:0xf bank_mask:0xf
  v_mov_b32_dpp v5, v42 quad_perm:[2,2,2,2] row_mask:0xf bank_mask:0xf
  s_nop 0
  v_add_f32_dpp v4, v41, v4 quad_perm:[1,1,1,1] row_mask:0xf bank_mask:0xf
  v_add_f32_dpp v5, v43, v5 quad_perm:[3,3,3,3] row_mask:0xf bank_mask:0xf
  v_add_f32 v4, v4, v5
  v_cvt_pk_bf16_f32 v4, v4, v4
  v_and_b32 v4, 0xffff0000, v4
  v_mul_f32 v4, 0x3db504f3, v4
  v_cvt_pk_bf16_f32 v68, v4, v4
  v_and_b32 v68, 0xffff0000, v68
  v_max_f32 v12, v12, v68
  ds_read_b128 v[224:227], v8 offset:24576
  ds_read_b128 v[228:231], v8 offset:25600
  ds_read_b128 v[232:235], v8 offset:26624
  ds_read_b128 v[236:239], v8 offset:27648
  s_waitcnt vmcnt(5)
  buffer_load_dwordx4 v[212:215], v2, s[40:43], s14 offen offset:1024 nt
  v_mfma_f32_16x16x32_bf16 v[40:43], v[96:99], v[16:19], 0
  v_mfma_f32_16x16x32_bf16 v[40:43], v[100:103], v[20:23], v[40:43]
  v_mfma_f32_16x16x32_bf16 v[40:43], v[104:107], v[24:27], v[40:43]
  v_mfma_f32_16x16x32_bf16 v[40:43], v[108:111], v[28:31], v[40:43]
  v_mov_b32_dpp v4, v36 quad_perm:[0,0,0,0] row_mask:0xf bank_mask:0xf
  v_mov_b32_dpp v5, v38 quad_perm:[2,2,2,2] row_mask:0xf bank_mask:0xf
  s_nop 0
  v_add_f32_dpp v4, v37, v4 quad_perm:[1,1,1,1] row_mask:0xf bank_mask:0xf
  v_add_f32_dpp v5, v39, v5 quad_perm:[3,3,3,3] row_mask:0xf bank_mask:0xf
  v_add_f32 v4, v4, v5
  v_cvt_pk_bf16_f32 v4, v4, v4
  v_and_b32 v4, 0xffff0000, v4
  v_mul_f32 v4, 0x3db504f3, v4
  v_cvt_pk_bf16_f32 v69, v4, v4
  v_and_b32 v69, 0xffff0000, v69
  v_max_f32 v12, v12, v69
  s_waitcnt vmcnt(5)
  buffer_load_dwordx4 v[216:219], v2, s[40:43], s14 offen offset:2048 nt
  s_waitcnt lgkmcnt(0)
  v_mfma_f32_16x16x32_bf16 v[36:39], v[224:227], v[16:19], 0
  v_mfma_f32_16x16x32_bf16 v[36:39], v[228:231], v[20:23], v[36:39]
  v_mfma_f32_16x16x32_bf16 v[36:39], v[232:235], v[24:27], v[36:39]
  v_mfma_f32_16x16x32_bf16 v[36:39], v[236:239], v[28:31], v[36:39]
  v_mov_b32_dpp v4, v40 quad_perm:[0,0,0,0] row_mask:0xf bank_mask:0xf
  v_mov_b32_dpp v5, v42 quad_perm:[2,2,2,2] row_mask:0xf bank_mask:0xf
  s_nop 0
  v_add_f32_dpp v4, v41, v4 quad_perm:[1,1,1,1] row_mask:0xf bank_mask:0xf
  v_add_f32_dpp v5, v43, v5 quad_perm:[3,3,3,3] row_mask:0xf bank_mask:0xf
  v_add_f32 v4, v4, v5
  v_cvt_pk_bf16_f32 v4, v4, v4
  v_and_b32 v4, 0xffff0000, v4
  v_mul_f32 v4, 0x3db504f3, v4
  v_cvt_pk_bf16_f32 v80, v4, v4
  v_and_b32 v80, 0xffff0000, v80
  v_max_f32 v12, v12, v80
  s_waitcnt vmcnt(5)
  buffer_load_dwordx4 v[220:223], v2, s[40:43], s14 offen offset:3072 nt
  s_waitcnt vmcnt(5)
  s_mov_b32 s14, 1196032
  buffer_load_dwordx4 v[112:115], v2, s[40:43], s14 offen offset:0 nt
  s_waitcnt vmcnt(5)
  buffer_load_dwordx4 v[116:119], v2, s[40:43], s14 offen offset:1024 nt
  v_mfma_f32_16x16x32_bf16 v[40:43], v[144:147], v[16:19], 0
  v_mfma_f32_16x16x32_bf16 v[40:43], v[148:151], v[20:23], v[40:43]
  v_mfma_f32_16x16x32_bf16 v[40:43], v[152:155], v[24:27], v[40:43]
  v_mfma_f32_16x16x32_bf16 v[40:43], v[156:159], v[28:31], v[40:43]
  v_mov_b32_dpp v4, v36 quad_perm:[0,0,0,0] row_mask:0xf bank_mask:0xf
  v_mov_b32_dpp v5, v38 quad_perm:[2,2,2,2] row_mask:0xf bank_mask:0xf
  s_nop 0
  v_add_f32_dpp v4, v37, v4 quad_perm:[1,1,1,1] row_mask:0xf bank_mask:0xf
  v_add_f32_dpp v5, v39, v5 quad_perm:[3,3,3,3] row_mask:0xf bank_mask:0xf
  v_add_f32 v4, v4, v5
  v_cvt_pk_bf16_f32 v4, v4, v4
  v_and_b32 v4, 0xffff0000, v4
  v_mul_f32 v4, 0x3db504f3, v4
  v_cvt_pk_bf16_f32 v70, v4, v4
  v_and_b32 v70, 0xffff0000, v70
  v_max_f32 v12, v12, v70
  s_waitcnt vmcnt(5)
  buffer_load_dwordx4 v[120:123], v2, s[40:43], s14 offen offset:2048 nt
  s_waitcnt vmcnt(5)
  buffer_load_dwordx4 v[124:127], v2, s[40:43], s14 offen offset:3072 nt
  s_waitcnt vmcnt(5)
  s_mov_b32 s14, 1310720
  buffer_load_dwordx4 v[128:131], v2, s[40:43], s14 offen offset:0 nt
  s_waitcnt vmcnt(5)
  buffer_load_dwordx4 v[132:135], v2, s[40:43], s14 offen offset:1024 nt
  v_mfma_f32_16x16x32_bf16 v[36:39], v[208:211], v[16:19], 0
  v_mfma_f32_16x16x32_bf16 v[36:39], v[212:215], v[20:23], v[36:39]
  v_mfma_f32_16x16x32_bf16 v[36:39], v[216:219], v[24:27], v[36:39]
  v_mfma_f32_16x16x32_bf16 v[36:39], v[220:223], v[28:31], v[36:39]
  v_mov_b32_dpp v4, v40 quad_perm:[0,0,0,0] row_mask:0xf bank_mask:0xf
  v_mov_b32_dpp v5, v42 quad_perm:[2,2,2,2] row_mask:0xf bank_mask:0xf
  s_nop 0
  v_add_f32_dpp v4, v41, v4 quad_perm:[1,1,1,1] row_mask:0xf bank_mask:0xf
  v_add_f32_dpp v5, v43, v5 quad_perm:[3,3,3,3] row_mask:0xf bank_mask:0xf
  v_add_f32 v4, v4, v5
  v_cvt_pk_bf16_f32 v4, v4, v4
  v_and_b32 v4, 0xffff0000, v4
  v_mul_f32 v4, 0x3db504f3, v4
  v_cvt_pk_bf16_f32 v81, v4, v4
  v_and_b32 v81, 0xffff0000, v81
  v_max_f32 v12, v12, v81
  s_waitcnt vmcnt(5)
  buffer_load_dwordx4 v[136:139], v2, s[40:43], s14 offen offset:2048 nt
  s_waitcnt vmcnt(5)
  buffer_load_dwordx4 v[140:143], v2, s[40:43], s14 offen offset:3072 nt
  s_waitcnt vmcnt(5)
  s_mov_b32 s14, 1327104
  buffer_load_dwordx4 v[240:243], v2, s[40:43], s14 offen offset:0 nt
  s_waitcnt vmcnt(5)
  buffer_load_dwordx4 v[244:247], v2, s[40:43], s14 offen offset:1024 nt
  v_mfma_f32_16x16x32_bf16 v[40:43], v[112:115], v[16:19], 0
  v_mfma_f32_16x16x32_bf16 v[40:43], v[116:119], v[20:23], v[40:43]
  v_mfma_f32_16x16x32_bf16 v[40:43], v[120:123], v[24:27], v[40:43]
  v_mfma_f32_16x16x32_bf16 v[40:43], v[124:127], v[28:31], v[40:43]
  v_mov_b32_dpp v4, v36 quad_perm:[0,0,0,0] row_mask:0xf bank_mask:0xf
  v_mov_b32_dpp v5, v38 quad_perm:[2,2,2,2] row_mask:0xf bank_mask:0xf
  s_nop 0
  v_add_f32_dpp v4, v37, v4 quad_perm:[1,1,1,1] row_mask:0xf bank_mask:0xf
  v_add_f32_dpp v5, v39, v5 quad_perm:[3,3,3,3] row_mask:0xf bank_mask:0xf
  v_add_f32 v4, v4, v5
  v_cvt_pk_bf16_f32 v4, v4, v4
  v_and_b32 v4, 0xffff0000, v4
  v_mul_f32 v4, 0x3db504f3, v4
  v_cvt_pk_bf16_f32 v82, v4, v4
  v_and_b32 v82, 0xffff0000, v82
  v_max_f32 v12, v12, v82
  s_waitcnt vmcnt(5)
  buffer_load_dwordx4 v[248:251], v2, s[40:43], s14 offen offset:2048 nt
  s_waitcnt vmcnt(5)
  buffer_load_dwordx4 v[252:255], v2, s[40:43], s14 offen offset:3072 nt
  s_waitcnt vmcnt(5)
  s_mov_b32 s14, 1441792
  buffer_load_dwordx4 v[160:163], v2, s[40:43], s14 offen offset:0 nt
  s_waitcnt vmcnt(5)
  buffer_load_dwordx4 v[164:167], v2, s[40:43], s14 offen offset:1024 nt
  v_mfma_f32_16x16x32_bf16 v[36:39], v[128:131], v[16:19], 0
  v_mfma_f32_16x16x32_bf16 v[36:39], v[132:135], v[20:23], v[36:39]
  v_mfma_f32_16x16x32_bf16 v[36:39], v[136:139], v[24:27], v[36:39]
  v_mfma_f32_16x16x32_bf16 v[36:39], v[140:143], v[28:31], v[36:39]
  v_mov_b32_dpp v4, v40 quad_perm:[0,0,0,0] row_mask:0xf bank_mask:0xf
  v_mov_b32_dpp v5, v42 quad_perm:[2,2,2,2] row_mask:0xf bank_mask:0xf
  s_nop 0
  v_add_f32_dpp v4, v41, v4 quad_perm:[1,1,1,1] row_mask:0xf bank_mask:0xf
  v_add_f32_dpp v5, v43, v5 quad_perm:[3,3,3,3] row_mask:0xf bank_mask:0xf
  v_add_f32 v4, v4, v5
  v_cvt_pk_bf16_f32 v4, v4, v4
  v_and_b32 v4, 0xffff0000, v4
  v_mul_f32 v4, 0x3db504f3, v4
  v_cvt_pk_bf16_f32 v83, v4, v4
  v_and_b32 v83, 0xffff0000, v83
  v_max_f32 v12, v12, v83
  s_waitcnt vmcnt(5)
  buffer_load_dwordx4 v[168:171], v2, s[40:43], s14 offen offset:2048 nt
  s_waitcnt vmcnt(5)
  buffer_load_dwordx4 v[172:175], v2, s[40:43], s14 offen offset:3072 nt
  s_waitcnt vmcnt(5)
  s_mov_b32 s14, 1458176
  buffer_load_dwordx4 v[176:179], v2, s[40:43], s14 offen offset:0 nt
  s_waitcnt vmcnt(5)
  buffer_load_dwordx4 v[180:183], v2, s[40:43], s14 offen offset:1024 nt
  v_mfma_f32_16x16x32_bf16 v[40:43], v[240:243], v[16:19], 0
  v_mfma_f32_16x16x32_bf16 v[40:43], v[244:247], v[20:23], v[40:43]
  v_mfma_f32_16x16x32_bf16 v[40:43], v[248:251], v[24:27], v[40:43]
  v_mfma_f32_16x16x32_bf16 v[40:43], v[252:255], v[28:31], v[40:43]
  v_mov_b32_dpp v4, v36 quad_perm:[0,0,0,0] row_mask:0xf bank_mask:0xf
  v_mov_b32_dpp v5, v38 quad_perm:[2,2,2,2] row_mask:0xf bank_mask:0xf
  s_nop 0
  v_add_f32_dpp v4, v37, v4 quad_perm:[1,1,1,1] row_mask:0xf bank_mask:0xf
  v_add_f32_dpp v5, v39, v5 quad_perm:[3,3,3,3] row_mask:0xf bank_mask:0xf
  v_add_f32 v4, v4, v5
  v_cvt_pk_bf16_f32 v4, v4, v4
  v_and_b32 v4, 0xffff0000, v4
  v_mul_f32 v4, 0x3db504f3, v4
  v_cvt_pk_bf16_f32 v84, v4, v4
  v_and_b32 v84, 0xffff0000, v84
  v_max_f32 v12, v12, v84
  s_waitcnt vmcnt(5)
  buffer_load_dwordx4 v[184:187], v2, s[40:43], s14 offen offset:2048 nt
  s_waitcnt vmcnt(5)
  buffer_load_dwordx4 v[188:191], v2, s[40:43], s14 offen offset:3072 nt
  s_waitcnt vmcnt(5)
  s_mov_b32 s14, 1572864
  buffer_load_dwordx4 v[192:195], v2, s[40:43], s14 offen offset:0 nt
  s_waitcnt vmcnt(5)
  buffer_load_dwordx4 v[196:199], v2, s[40:43], s14 offen offset:1024 nt
  v_mfma_f32_16x16x32_bf16 v[36:39], v[160:163], v[16:19], 0
  v_mfma_f32_16x16x32_bf16 v[36:39], v[164:167], v[20:23], v[36:39]
  v_mfma_f32_16x16x32_bf16 v[36:39], v[168:171], v[24:27], v[36:39]
  v_mfma_f32_16x16x32_bf16 v[36:39], v[172:175], v[28:31], v[36:39]
  v_mov_b32_dpp v4, v40 quad_perm:[0,0,0,0] row_mask:0xf bank_mask:0xf
  v_mov_b32_dpp v5, v42 quad_perm:[2,2,2,2] row_mask:0xf bank_mask:0xf
  s_nop 0
  v_add_f32_dpp v4, v41, v4 quad_perm:[1,1,1,1] row_mask:0xf bank_mask:0xf
  v_add_f32_dpp v5, v43, v5 quad_perm:[3,3,3,3] row_mask:0xf bank_mask:0xf
  v_add_f32 v4, v4, v5
  v_cvt_pk_bf16_f32 v4, v4, v4
  v_and_b32 v4, 0xffff0000, v4
  v_mul_f32 v4, 0x3db504f3, v4
  v_cvt_pk_bf16_f32 v85, v4, v4
  v_and_b32 v85, 0xffff0000, v85
  v_max_f32 v12, v12, v85
  s_waitcnt vmcnt(5)
  buffer_load_dwordx4 v[200:203], v2, s[40:43], s14 offen offset:2048 nt
  s_waitcnt vmcnt(5)
  buffer_load_dwordx4 v[204:207], v2, s[40:43], s14 offen offset:3072 nt
  s_waitcnt vmcnt(5)
  s_mov_b32 s14, 1589248
  buffer_load_dwordx4 v[96:99], v2, s[40:43], s14 offen offset:0 nt
  s_waitcnt vmcnt(5)
  buffer_load_dwordx4 v[100:103], v2, s[40:43], s14 offen offset:1024 nt
  v_mfma_f32_16x16x32_bf16 v[40:43], v[176:179], v[16:19], 0
  v_mfma_f32_16x16x32_bf16 v[40:43], v[180:183], v[20:23], v[40:43]
  v_mfma_f32_16x16x32_bf16 v[40:43], v[184:187], v[24:27], v[40:43]
  v_mfma_f32_16x16x32_bf16 v[40:43], v[188:191], v[28:31], v[40:43]
  v_mov_b32_dpp v4, v36 quad_perm:[0,0,0,0] row_mask:0xf bank_mask:0xf
  v_mov_b32_dpp v5, v38 quad_perm:[2,2,2,2] row_mask:0xf bank_mask:0xf
  s_nop 0
  v_add_f32_dpp v4, v37, v4 quad_perm:[1,1,1,1] row_mask:0xf bank_mask:0xf
  v_add_f32_dpp v5, v39, v5 quad_perm:[3,3,3,3] row_mask:0xf bank_mask:0xf
  v_add_f32 v4, v4, v5
  v_cvt_pk_bf16_f32 v4, v4, v4
  v_and_b32 v4, 0xffff0000, v4
  v_mul_f32 v4, 0x3db504f3, v4
  v_cvt_pk_bf16_f32 v86, v4, v4
  v_and_b32 v86, 0xffff0000, v86
  v_max_f32 v12, v12, v86
  s_waitcnt vmcnt(5)
  buffer_load_dwordx4 v[104:107], v2, s[40:43], s14 offen offset:2048 nt
  s_waitcnt vmcnt(5)
  buffer_load_dwordx4 v[108:111], v2, s[40:43], s14 offen offset:3072 nt
  s_waitcnt vmcnt(5)
  s_mov_b32 s14, 1703936
  buffer_load_dwordx4 v[224:227], v2, s[40:43], s14 offen offset:0 nt
  s_waitcnt vmcnt(5)
  buffer_load_dwordx4 v[228:231], v2, s[40:43], s14 offen offset:1024 nt
  v_mfma_f32_16x16x32_bf16 v[36:39], v[192:195], v[16:19], 0
  v_mfma_f32_16x16x32_bf16 v[36:39], v[196:199], v[20:23], v[36:39]
  v_mfma_f32_16x16x32_bf16 v[36:39], v[200:203], v[24:27], v[36:39]
  v_mfma_f32_16x16x32_bf16 v[36:39], v[204:207], v[28:31], v[36:39]
  v_mov_b32_dpp v4, v40 quad_perm:[0,0,0,0] row_mask:0xf bank_mask:0xf
  v_mov_b32_dpp v5, v42 quad_perm:[2,2,2,2] row_mask:0xf bank_mask:0xf
  s_nop 0
  v_add_f32_dpp v4, v41, v4 quad_perm:[1,1,1,1] row_mask:0xf bank_mask:0xf
  v_add_f32_dpp v5, v43, v5 quad_perm:[3,3,3,3] row_mask:0xf bank_mask:0xf
  v_add_f32 v4, v4, v5
  v_cvt_pk_bf16_f32 v4, v4, v4
  v_and_b32 v4, 0xffff0000, v4
  v_mul_f32 v4, 0x3db504f3, v4
  v_cvt_pk_bf16_f32 v87, v4, v4
  v_and_b32 v87, 0xffff0000, v87
  v_max_f32 v12, v12, v87
  s_waitcnt vmcnt(5)
  buffer_load_dwordx4 v[232:235], v2, s[40:43], s14 offen offset:2048 nt
  s_waitcnt vmcnt(5)
  buffer_load_dwordx4 v[236:239], v2, s[40:43], s14 offen offset:3072 nt
  s_waitcnt vmcnt(5)
  s_mov_b32 s14, 1720320
  buffer_load_dwordx4 v[144:147], v2, s[40:43], s14 offen offset:0 nt
  s_waitcnt vmcnt(5)
  buffer_load_dwordx4 v[148:151], v2, s[40:43], s14 offen offset:1024 nt
  v_mfma_f32_16x16x32_bf16 v[40:43], v[96:99], v[16:19], 0
  v_mfma_f32_16x16x32_bf16 v[40:43], v[100:103], v[20:23], v[40:43]
  v_mfma_f32_16x16x32_bf16 v[40:43], v[104:107], v[24:27], v[40:43]
  v_mfma_f32_16x16x32_bf16 v[40:43], v[108:111], v[28:31], v[40:43]
  v_mov_b32_dpp v4, v36 quad_perm:[0,0,0,0] row_mask:0xf bank_mask:0xf
  v_mov_b32_dpp v5, v38 quad_perm:[2,2,2,2] row_mask:0xf bank_mask:0xf
  s_nop 0
  v_add_f32_dpp v4, v37, v4 quad_perm:[1,1,1,1] row_mask:0xf bank_mask:0xf
  v_add_f32_dpp v5, v39, v5 quad_perm:[3,3,3,3] row_mask:0xf bank_mask:0xf
  v_add_f32 v4, v4, v5
  v_cvt_pk_bf16_f32 v4, v4, v4
  v_and_b32 v4, 0xffff0000, v4
  v_mul_f32 v4, 0x3db504f3, v4
  v_cvt_pk_bf16_f32 v88, v4, v4
  v_and_b32 v88, 0xffff0000, v88
  v_max_f32 v12, v12, v88
  s_waitcnt vmcnt(5)
  buffer_load_dwordx4 v[152:155], v2, s[40:43], s14 offen offset:2048 nt
  s_waitcnt vmcnt(5)
  buffer_load_dwordx4 v[156:159], v2, s[40:43], s14 offen offset:3072 nt
  s_waitcnt vmcnt(5)
  s_mov_b32 s14, 1835008
  buffer_load_dwordx4 v[208:211], v2, s[40:43], s14 offen offset:0 nt
  s_waitcnt vmcnt(5)
  buffer_load_dwordx4 v[212:215], v2, s[40:43], s14 offen offset:1024 nt
  v_mfma_f32_16x16x32_bf16 v[36:39], v[224:227], v[16:19], 0
  v_mfma_f32_16x16x32_bf16 v[36:39], v[228:231], v[20:23], v[36:39]
  v_mfma_f32_16x16x32_bf16 v[36:39], v[232:235], v[24:27], v[36:39]
  v_mfma_f32_16x16x32_bf16 v[36:39], v[236:239], v[28:31], v[36:39]
  v_mov_b32_dpp v4, v40 quad_perm:[0,0,0,0] row_mask:0xf bank_mask:0xf
  v_mov_b32_dpp v5, v42 quad_perm:[2,2,2,2] row_mask:0xf bank_mask:0xf
  s_nop 0
  v_add_f32_dpp v4, v41, v4 quad_perm:[1,1,1,1] row_mask:0xf bank_mask:0xf
  v_add_f32_dpp v5, v43, v5 quad_perm:[3,3,3,3] row_mask:0xf bank_mask:0xf
  v_add_f32 v4, v4, v5
  v_cvt_pk_bf16_f32 v4, v4, v4
  v_and_b32 v4, 0xffff0000, v4
  v_mul_f32 v4, 0x3db504f3, v4
  v_cvt_pk_bf16_f32 v89, v4, v4
  v_and_b32 v89, 0xffff0000, v89
  v_max_f32 v12, v12, v89
  s_waitcnt vmcnt(5)
  buffer_load_dwordx4 v[216:219], v2, s[40:43], s14 offen offset:2048 nt
  s_waitcnt vmcnt(5)
  buffer_load_dwordx4 v[220:223], v2, s[40:43], s14 offen offset:3072 nt
  s_waitcnt vmcnt(5)
  s_mov_b32 s14, 1851392
  buffer_load_dwordx4 v[112:115], v2, s[40:43], s14 offen offset:0 nt
  s_waitcnt vmcnt(5)
  buffer_load_dwordx4 v[116:119], v2, s[40:43], s14 offen offset:1024 nt
  v_mfma_f32_16x16x32_bf16 v[40:43], v[144:147], v[16:19], 0
  v_mfma_f32_16x16x32_bf16 v[40:43], v[148:151], v[20:23], v[40:43]
  v_mfma_f32_16x16x32_bf16 v[40:43], v[152:155], v[24:27], v[40:43]
  v_mfma_f32_16x16x32_bf16 v[40:43], v[156:159], v[28:31], v[40:43]
  v_mov_b32_dpp v4, v36 quad_perm:[0,0,0,0] row_mask:0xf bank_mask:0xf
  v_mov_b32_dpp v5, v38 quad_perm:[2,2,2,2] row_mask:0xf bank_mask:0xf
  s_nop 0
  v_add_f32_dpp v4, v37, v4 quad_perm:[1,1,1,1] row_mask:0xf bank_mask:0xf
  v_add_f32_dpp v5, v39, v5 quad_perm:[3,3,3,3] row_mask:0xf bank_mask:0xf
  v_add_f32 v4, v4, v5
  v_cvt_pk_bf16_f32 v4, v4, v4
  v_and_b32 v4, 0xffff0000, v4
  v_mul_f32 v4, 0x3db504f3, v4
  v_cvt_pk_bf16_f32 v90, v4, v4
  v_and_b32 v90, 0xffff0000, v90
  v_max_f32 v12, v12, v90
  s_waitcnt vmcnt(5)
  buffer_load_dwordx4 v[120:123], v2, s[40:43], s14 offen offset:2048 nt
  s_waitcnt vmcnt(5)
  buffer_load_dwordx4 v[124:127], v2, s[40:43], s14 offen offset:3072 nt
  s_waitcnt vmcnt(5)
  s_mov_b32 s14, 1966080
  buffer_load_dwordx4 v[128:131], v2, s[40:43], s14 offen offset:0 nt
  s_waitcnt vmcnt(5)
  buffer_load_dwordx4 v[132:135], v2, s[40:43], s14 offen offset:1024 nt
  v_mfma_f32_16x16x32_bf16 v[36:39], v[208:211], v[16:19], 0
  v_mfma_f32_16x16x32_bf16 v[36:39], v[212:215], v[20:23], v[36:39]
  v_mfma_f32_16x16x32_bf16 v[36:39], v[216:219], v[24:27], v[36:39]
  v_mfma_f32_16x16x32_bf16 v[36:39], v[220:223], v[28:31], v[36:39]
  v_mov_b32_dpp v4, v40 quad_perm:[0,0,0,0] row_mask:0xf bank_mask:0xf
  v_mov_b32_dpp v5, v42 quad_perm:[2,2,2,2] row_mask:0xf bank_mask:0xf
  s_nop 0
  v_add_f32_dpp v4, v41, v4 quad_perm:[1,1,1,1] row_mask:0xf bank_mask:0xf
  v_add_f32_dpp v5, v43, v5 quad_perm:[3,3,3,3] row_mask:0xf bank_mask:0xf
  v_add_f32 v4, v4, v5
  v_cvt_pk_bf16_f32 v4, v4, v4
  v_and_b32 v4, 0xffff0000, v4
  v_mul_f32 v4, 0x3db504f3, v4
  v_cvt_pk_bf16_f32 v91, v4, v4
  v_and_b32 v91, 0xffff0000, v91
  v_max_f32 v12, v12, v91
  s_waitcnt vmcnt(5)
  buffer_load_dwordx4 v[136:139], v2, s[40:43], s14 offen offset:2048 nt
  s_waitcnt vmcnt(5)
  buffer_load_dwordx4 v[140:143], v2, s[40:43], s14 offen offset:3072 nt
  s_waitcnt vmcnt(5)
  s_mov_b32 s14, 1982464
  buffer_load_dwordx4 v[240:243], v2, s[40:43], s14 offen offset:0 nt
  s_waitcnt vmcnt(5)
  buffer_load_dwordx4 v[244:247], v2, s[40:43], s14 offen offset:1024 nt
  v_mfma_f32_16x16x32_bf16 v[40:43], v[112:115], v[16:19], 0
  v_mfma_f32_16x16x32_bf16 v[40:43], v[116:119], v[20:23], v[40:43]
  v_mfma_f32_16x16x32_bf16 v[40:43], v[120:123], v[24:27], v[40:43]
  v_mfma_f32_16x16x32_bf16 v[40:43], v[124:127], v[28:31], v[40:43]
  v_mov_b32_dpp v4, v36 quad_perm:[0,0,0,0] row_mask:0xf bank_mask:0xf
  v_mov_b32_dpp v5, v38 quad_perm:[2,2,2,2] row_mask:0xf bank_mask:0xf
  s_nop 0
  v_add_f32_dpp v4, v37, v4 quad_perm:[1,1,1,1] row_mask:0xf bank_mask:0xf
  v_add_f32_dpp v5, v39, v5 quad_perm:[3,3,3,3] row_mask:0xf bank_mask:0xf
  v_add_f32 v4, v4, v5
  v_cvt_pk_bf16_f32 v4, v4, v4
  v_and_b32 v4, 0xffff0000, v4
  v_mul_f32 v4, 0x3db504f3, v4
  v_cvt_pk_bf16_f32 v92, v4, v4
  v_and_b32 v92, 0xffff0000, v92
  v_max_f32 v12, v12, v92
  s_waitcnt vmcnt(5)
  buffer_load_dwordx4 v[248:251], v2, s[40:43], s14 offen offset:2048 nt
  s_waitcnt vmcnt(5)
  buffer_load_dwordx4 v[252:255], v2, s[40:43], s14 offen offset:3072 nt
  s_waitcnt vmcnt(5)
  buffer_load_dwordx4 v[160:163], v3, s[44:47], 0 offen offset:0 nt
  s_waitcnt vmcnt(5)
  buffer_load_dwordx4 v[164:167], v3, s[44:47], 0 offen offset:1024 nt
  v_mfma_f32_16x16x32_bf16 v[36:39], v[128:131], v[16:19], 0
  v_mfma_f32_16x16x32_bf16 v[36:39], v[132:135], v[20:23], v[36:39]
  v_mfma_f32_16x16x32_bf16 v[36:39], v[136:139], v[24:27], v[36:39]
  v_mfma_f32_16x16x32_bf16 v[36:39], v[140:143], v[28:31], v[36:39]
  v_mov_b32_dpp v4, v40 quad_perm:[0,0,0,0] row_mask:0xf bank_mask:0xf
  v_mov_b32_dpp v5, v42 quad_perm:[2,2,2,2] row_mask:0xf bank_mask:0xf
  s_nop 0
  v_add_f32_dpp v4, v41, v4 quad_perm:[1,1,1,1] row_mask:0xf bank_mask:0xf
  v_add_f32_dpp v5, v43, v5 quad_perm:[3,3,3,3] row_mask:0xf bank_mask:0xf
  v_add_f32 v4, v4, v5
  v_cvt_pk_bf16_f32 v4, v4, v4
  v_and_b32 v4, 0xffff0000, v4
  v_mul_f32 v4, 0x3db504f3, v4
  v_cvt_pk_bf16_f32 v93, v4, v4
  v_and_b32 v93, 0xffff0000, v93
  v_max_f32 v12, v12, v93
  s_waitcnt vmcnt(5)
  buffer_load_dwordx4 v[168:171], v3, s[44:47], 0 offen offset:2048 nt
  s_waitcnt vmcnt(5)
  buffer_load_dwordx4 v[172:175], v3, s[44:47], 0 offen offset:3072 nt
  s_waitcnt vmcnt(5)
  s_mov_b32 s14, 16384
  buffer_load_dwordx4 v[176:179], v3, s[44:47], s14 offen offset:0 nt
  s_waitcnt vmcnt(5)
  buffer_load_dwordx4 v[180:183], v3, s[44:47], s14 offen offset:1024 nt
  v_mfma_f32_16x16x32_bf16 v[40:43], v[240:243], v[16:19], 0
  v_mfma_f32_16x16x32_bf16 v[40:43], v[244:247], v[20:23], v[40:43]
  v_mfma_f32_16x16x32_bf16 v[40:43], v[248:251], v[24:27], v[40:43]
  v_mfma_f32_16x16x32_bf16 v[40:43], v[252:255], v[28:31], v[40:43]
  v_mov_b32_dpp v4, v36 quad_perm:[0,0,0,0] row_mask:0xf bank_mask:0xf
  v_mov_b32_dpp v5, v38 quad_perm:[2,2,2,2] row_mask:0xf bank_mask:0xf
  s_nop 0
  v_add_f32_dpp v4, v37, v4 quad_perm:[1,1,1,1] row_mask:0xf bank_mask:0xf
  v_add_f32_dpp v5, v39, v5 quad_perm:[3,3,3,3] row_mask:0xf bank_mask:0xf
  v_add_f32 v4, v4, v5
  v_cvt_pk_bf16_f32 v4, v4, v4
  v_and_b32 v4, 0xffff0000, v4
  v_mul_f32 v4, 0x3db504f3, v4
  v_cvt_pk_bf16_f32 v94, v4, v4
  v_and_b32 v94, 0xffff0000, v94
  v_max_f32 v12, v12, v94
  v_mov_b32_dpp v4, v40 quad_perm:[0,0,0,0] row_mask:0xf bank_mask:0xf
  v_mov_b32_dpp v5, v42 quad_perm:[2,2,2,2] row_mask:0xf bank_mask:0xf
  s_nop 0
  v_add_f32_dpp v4, v41, v4 quad_perm:[1,1,1,1] row_mask:0xf bank_mask:0xf
  v_add_f32_dpp v5, v43, v5 quad_perm:[3,3,3,3] row_mask:0xf bank_mask:0xf
  v_add_f32 v4, v4, v5
  v_cvt_pk_bf16_f32 v4, v4, v4
  v_and_b32 v4, 0xffff0000, v4
  v_mul_f32 v4, 0x3db504f3, v4
  v_cvt_pk_bf16_f32 v95, v4, v4
  v_and_b32 v95, 0xffff0000, v95
  v_max_f32 v12, v12, v95
  s_nop 1
  v_max_f32_dpp v12, v12, v12 row_ror:4 row_mask:0xf bank_mask:0xf
  s_nop 1
  v_max_f32_dpp v12, v12, v12 row_ror:8 row_mask:0xf bank_mask:0xf
  v_mov_b32 v4, v12
  s_nop 1
  v_permlane32_swap_b32 v12, v4
  v_max_f32 v12, v12, v4
  v_mov_b32 v4, v12
  s_nop 1
  v_permlane16_swap_b32 v12, v4
  v_max_f32 v12, v12, v4
  v_mul_f32 v13, 0x3fb8aa3b, v12
  s_mov_b32 s10, 0x3fb8aa3b
  v_mov_b32 v14, 0
  v_mov_b32 v15, 0
  s_waitcnt vmcnt(5)
  buffer_load_dwordx4 v[184:187], v3, s[44:47], s14 offen offset:2048 nt
  v_fma_f32 v4, v64, s10, -v13
  v_fma_f32 v5, v65, s10, -v13
  v_exp_f32 v4, v4
  v_exp_f32 v5, v5
  v_add_f32 v14, v14, v4
  v_add_f32 v15, v15, v5
  v_cvt_pk_bf16_f32 v64, v4, v4
  v_cvt_pk_bf16_f32 v65, v5, v5
  v_fma_f32 v4, v66, s10, -v13
  v_fma_f32 v5, v67, s10, -v13
  v_exp_f32 v4, v4
  v_exp_f32 v5, v5
  v_add_f32 v14, v14, v4
  v_add_f32 v15, v15, v5
  v_cvt_pk_bf16_f32 v66, v4, v4
  v_cvt_pk_bf16_f32 v67, v5, v5
  v_fma_f32 v4, v68, s10, -v13
  v_fma_f32 v5, v69, s10, -v13
  v_exp_f32 v4, v4
  v_exp_f32 v5, v5
  v_add_f32 v14, v14, v4
  v_add_f32 v15, v15, v5
  v_cvt_pk_bf16_f32 v68, v4, v4
  v_cvt_pk_bf16_f32 v69, v5, v5
  v_fma_f32 v4, v70, s10, -v13
  v_fma_f32 v5, v71, s10, -v13
  v_exp_f32 v4, v4
  v_exp_f32 v5, v5
  v_add_f32 v14, v14, v4
  v_add_f32 v15, v15, v5
  v_cvt_pk_bf16_f32 v70, v4, v4
  v_cvt_pk_bf16_f32 v71, v5, v5
  s_waitcnt vmcnt(5)
  buffer_load_dwordx4 v[188:191], v3, s[44:47], s14 offen offset:3072 nt
  v_fma_f32 v4, v72, s10, -v13
  v_fma_f32 v5, v73, s10, -v13
  v_exp_f32 v4, v4
  v_exp_f32 v5, v5
  v_add_f32 v14, v14, v4
  v_add_f32 v15, v15, v5
  v_cvt_pk_bf16_f32 v72, v4, v4
  v_cvt_pk_bf16_f32 v73, v5, v5
  v_fma_f32 v4, v74, s10, -v13
  v_fma_f32 v5, v75, s10, -v13
  v_exp_f32 v4, v4
  v_exp_f32 v5, v5
  v_add_f32 v14, v14, v4
  v_add_f32 v15, v15, v5
  v_cvt_pk_bf16_f32 v74, v4, v4
  v_cvt_pk_bf16_f32 v75, v5, v5
  v_fma_f32 v4, v76, s10, -v13
  v_fma_f32 v5, v77, s10, -v13
  v_exp_f32 v4, v4
  v_exp_f32 v5, v5
  v_add_f32 v14, v14, v4
  v_add_f32 v15, v15, v5
  v_cvt_pk_bf16_f32 v76, v4, v4
  v_cvt_pk_bf16_f32 v77, v5, v5
  v_fma_f32 v4, v78, s10, -v13
  v_fma_f32 v5, v79, s10, -v13
  v_exp_f32 v4, v4
  v_exp_f32 v5, v5
  v_add_f32 v14, v14, v4
  v_add_f32 v15, v15, v5
  v_cvt_pk_bf16_f32 v78, v4, v4
  v_cvt_pk_bf16_f32 v79, v5, v5
  s_waitcnt vmcnt(5)
  s_mov_b32 s14, 131072
  buffer_load_dwordx4 v[192:195], v3, s[44:47], s14 offen offset:0 nt
  v_fma_f32 v4, v80, s10, -v13
  v_fma_f32 v5, v81, s10, -v13
  v_exp_f32 v4, v4
  v_exp_f32 v5, v5
  v_add_f32 v14, v14, v4
  v_add_f32 v15, v15, v5
  v_cvt_pk_bf16_f32 v80, v4, v4
  v_cvt_pk_bf16_f32 v81, v5, v5
  v_fma_f32 v4, v82, s10, -v13
  v_fma_f32 v5, v83, s10, -v13
  v_exp_f32 v4, v4
  v_exp_f32 v5, v5
  v_add_f32 v14, v14, v4
  v_add_f32 v15, v15, v5
  v_cvt_pk_bf16_f32 v82, v4, v4
  v_cvt_pk_bf16_f32 v83, v5, v5
  v_fma_f32 v4, v84, s10, -v13
  v_fma_f32 v5, v85, s10, -v13
  v_exp_f32 v4, v4
  v_exp_f32 v5, v5
  v_add_f32 v14, v14, v4
  v_add_f32 v15, v15, v5
  v_cvt_pk_bf16_f32 v84, v4, v4
  v_cvt_pk_bf16_f32 v85, v5, v5
  v_fma_f32 v4, v86, s10, -v13
  v_fma_f32 v5, v87, s10, -v13
  v_exp_f32 v4, v4
  v_exp_f32 v5, v5
  v_add_f32 v14, v14, v4
  v_add_f32 v15, v15, v5
  v_cvt_pk_bf16_f32 v86, v4, v4
  v_cvt_pk_bf16_f32 v87, v5, v5
  s_waitcnt vmcnt(5)
  buffer_load_dwordx4 v[196:199], v3, s[44:47], s14 offen offset:1024 nt
  v_fma_f32 v4, v88, s10, -v13
  v_fma_f32 v5, v89, s10, -v13
  v_exp_f32 v4, v4
  v_exp_f32 v5, v5
  v_add_f32 v14, v14, v4
  v_add_f32 v15, v15, v5
  v_cvt_pk_bf16_f32 v88, v4, v4
  v_cvt_pk_bf16_f32 v89, v5, v5
  v_fma_f32 v4, v90, s10, -v13
  v_fma_f32 v5, v91, s10, -v13
  v_exp_f32 v4, v4
  v_exp_f32 v5, v5
  v_add_f32 v14, v14, v4
  v_add_f32 v15, v15, v5
  v_cvt_pk_bf16_f32 v90, v4, v4
  v_cvt_pk_bf16_f32 v91, v5, v5
  v_fma_f32 v4, v92, s10, -v13
  v_fma_f32 v5, v93, s10, -v13
  v_exp_f32 v4, v4
  v_exp_f32 v5, v5
  v_add_f32 v14, v14, v4
  v_add_f32 v15, v15, v5
  v_cvt_pk_bf16_f32 v92, v4, v4
  v_cvt_pk_bf16_f32 v93, v5, v5
  v_fma_f32 v4, v94, s10, -v13
  v_fma_f32 v5, v95, s10, -v13
  v_exp_f32 v4, v4
  v_exp_f32 v5, v5
  v_add_f32 v14, v14, v4
  v_add_f32 v15, v15, v5
  v_cvt_pk_bf16_f32 v94, v4, v4
  v_cvt_pk_bf16_f32 v95, v5, v5
  s_waitcnt vmcnt(5)
  buffer_load_dwordx4 v[200:203], v3, s[44:47], s14 offen offset:2048 nt
  v_add_f32 v14, v14, v15
  s_nop 1
  v_add_f32_dpp v14, v14, v14 row_ror:4 row_mask:0xf bank_mask:0xf
  s_nop 1
  v_add_f32_dpp v14, v14, v14 row_ror:8 row_mask:0xf bank_mask:0xf
  v_mov_b32 v4, v14
  s_nop 1
  v_permlane32_swap_b32 v14, v4
  v_add_f32 v14, v14, v4
  v_mov_b32 v4, v14
  s_nop 1
  v_permlane16_swap_b32 v14, v4
  v_add_f32 v14, v14, v4
  v_lshlrev_b32 v8, 4, v11
  v_lshl_add_u32 v8, v10, 3, v8
  s_lshl_b32 s10, s3, 8
  s_add_u32 s10, s10, 153600
  v_add_u32 v8, s10, v8
  s_waitcnt vmcnt(5)
  buffer_load_dwordx4 v[204:207], v3, s[44:47], s14 offen offset:3072 nt
  v_and_b32_dpp v48, v64, v32 row_newbcast:0 row_mask:0xf bank_mask:0xf
  v_and_b32_dpp v49, v64, v33 row_newbcast:0 row_mask:0xf bank_mask:0xf
  v_and_b32_dpp v50, v64, v34 row_newbcast:0 row_mask:0xf bank_mask:0xf
  v_and_b32_dpp v51, v64, v35 row_newbcast:0 row_mask:0xf bank_mask:0xf
  s_nop 1
  v_mfma_f32_16x16x32_bf16 v[44:47], v[48:51], v[160:163], 0
  v_and_b32_dpp v52, v64, v32 row_newbcast:4 row_mask:0xf bank_mask:0xf
  v_and_b32_dpp v53, v64, v33 row_newbcast:4 row_mask:0xf bank_mask:0xf
  v_and_b32_dpp v54, v64, v34 row_newbcast:4 row_mask:0xf bank_mask:0xf
  v_and_b32_dpp v55, v64, v35 row_newbcast:4 row_mask:0xf bank_mask:0xf
  s_nop 1
  v_mfma_f32_16x16x32_bf16 v[44:47], v[52:55], v[164:167], v[44:47]
  v_and_b32_dpp v48, v64, v32 row_newbcast:8 row_mask:0xf bank_mask:0xf
  v_and_b32_dpp v49, v64, v33 row_newbcast:8 row_mask:0xf bank_mask:0xf
  v_and_b32_dpp v50, v64, v34 row_newbcast:8 row_mask:0xf bank_mask:0xf
  v_and_b32_dpp v51, v64, v35 row_newbcast:8 row_mask:0xf bank_mask:0xf
  s_nop 1
  v_mfma_f32_16x16x32_bf16 v[44:47], v[48:51], v[168:171], v[44:47]
  v_and_b32_dpp v52, v64, v32 row_newbcast:12 row_mask:0xf bank_mask:0xf
  v_and_b32_dpp v53, v64, v33 row_newbcast:12 row_mask:0xf bank_mask:0xf
  v_and_b32_dpp v54, v64, v34 row_newbcast:12 row_mask:0xf bank_mask:0xf
  v_and_b32_dpp v55, v64, v35 row_newbcast:12 row_mask:0xf bank_mask:0xf
  s_nop 1
  v_mfma_f32_16x16x32_bf16 v[44:47], v[52:55], v[172:175], v[44:47]
  s_waitcnt vmcnt(5)
  s_mov_b32 s14, 147456
  buffer_load_dwordx4 v[96:99], v3, s[44:47], s14 offen offset:0 nt
  ds_add_u32 v63, v0 offset:20
L_acw_3:
  v_and_b32_dpp v48, v65, v32 row_newbcast:0 row_mask:0xf bank_mask:0xf
  v_and_b32_dpp v49, v65, v33 row_newbcast:0 row_mask:0xf bank_mask:0xf
  v_and_b32_dpp v50, v65, v34 row_newbcast:0 row_mask:0xf bank_mask:0xf
  v_and_b32_dpp v51, v65, v35 row_newbcast:0 row_mask:0xf bank_mask:0xf
  s_nop 1
  v_mfma_f32_16x16x32_bf16 v[44:47], v[48:51], v[176:179], v[44:47]
  v_and_b32_dpp v52, v65, v32 row_newbcast:4 row_mask:0xf bank_mask:0xf
  v_and_b32_dpp v53, v65, v33 row_newbcast:4 row_mask:0xf bank_mask:0xf
  v_and_b32_dpp v54, v65, v34 row_newbcast:4 row_mask:0xf bank_mask:0xf
  v_and_b32_dpp v55, v65, v35 row_newbcast:4 row_mask:0xf bank_mask:0xf
  s_nop 1
  v_mfma_f32_16x16x32_bf16 v[44:47], v[52:55], v[180:183], v[44:47]
  v_and_b32_dpp v48, v65, v32 row_newbcast:8 row_mask:0xf bank_mask:0xf
  v_and_b32_dpp v49, v65, v33 row_newbcast:8 row_mask:0xf bank_mask:0xf
  v_and_b32_dpp v50, v65, v34 row_newbcast:8 row_mask:0xf bank_mask:0xf
  v_and_b32_dpp v51, v65, v35 row_newbcast:8 row_mask:0xf bank_mask:0xf
  s_nop 1
  v_mfma_f32_16x16x32_bf16 v[44:47], v[48:51], v[184:187], v[44:47]
  s_waitcnt vmcnt(5)
  buffer_load_dwordx4 v[100:103], v3, s[44:47], s14 offen offset:1024 nt
  v_and_b32_dpp v52, v65, v32 row_newbcast:12 row_mask:0xf bank_mask:0xf
  v_and_b32_dpp v53, v65, v33 row_newbcast:12 row_mask:0xf bank_mask:0xf
  v_and_b32_dpp v54, v65, v34 row_newbcast:12 row_mask:0xf bank_mask:0xf
  v_and_b32_dpp v55, v65, v35 row_newbcast:12 row_mask:0xf bank_mask:0xf
  s_nop 1
  v_mfma_f32_16x16x32_bf16 v[44:47], v[52:55], v[188:191], v[44:47]
  s_waitcnt vmcnt(5)
  buffer_load_dwordx4 v[104:107], v3, s[44:47], s14 offen offset:2048 nt
  v_and_b32_dpp v48, v66, v32 row_newbcast:0 row_mask:0xf bank_mask:0xf
  v_and_b32_dpp v49, v66, v33 row_newbcast:0 row_mask:0xf bank_mask:0xf
  v_and_b32_dpp v50, v66, v34 row_newbcast:0 row_mask:0xf bank_mask:0xf
  v_and_b32_dpp v51, v66, v35 row_newbcast:0 row_mask:0xf bank_mask:0xf
  s_nop 1
  v_mfma_f32_16x16x32_bf16 v[44:47], v[48:51], v[192:195], v[44:47]
  s_waitcnt vmcnt(5)
  buffer_load_dwordx4 v[108:111], v3, s[44:47], s14 offen offset:3072 nt
  v_and_b32_dpp v52, v66, v32 row_newbcast:4 row_mask:0xf bank_mask:0xf
  v_and_b32_dpp v53, v66, v33 row_newbcast:4 row_mask:0xf bank_mask:0xf
  v_and_b32_dpp v54, v66, v34 row_newbcast:4 row_mask:0xf bank_mask:0xf
  v_and_b32_dpp v55, v66, v35 row_newbcast:4 row_mask:0xf bank_mask:0xf
  s_nop 1
  v_mfma_f32_16x16x32_bf16 v[44:47], v[52:55], v[196:199], v[44:47]
  s_waitcnt vmcnt(5)
  s_mov_b32 s14, 262144
  buffer_load_dwordx4 v[224:227], v3, s[44:47], s14 offen offset:0 nt
  v_and_b32_dpp v48, v66, v32 row_newbcast:8 row_mask:0xf bank_mask:0xf
  v_and_b32_dpp v49, v66, v33 row_newbcast:8 row_mask:0xf bank_mask:0xf
  v_and_b32_dpp v50, v66, v34 row_newbcast:8 row_mask:0xf bank_mask:0xf
  v_and_b32_dpp v51, v66, v35 row_newbcast:8 row_mask:0xf bank_mask:0xf
  s_nop 1
  v_mfma_f32_16x16x32_bf16 v[44:47], v[48:51], v[200:203], v[44:47]
  s_waitcnt vmcnt(5)
  buffer_load_dwordx4 v[228:231], v3, s[44:47], s14 offen offset:1024 nt
  v_and_b32_dpp v52, v66, v32 row_newbcast:12 row_mask:0xf bank_mask:0xf
  v_and_b32_dpp v53, v66, v33 row_newbcast:12 row_mask:0xf bank_mask:0xf
  v_and_b32_dpp v54, v66, v34 row_newbcast:12 row_mask:0xf bank_mask:0xf
  v_and_b32_dpp v55, v66, v35 row_newbcast:12 row_mask:0xf bank_mask:0xf
  s_nop 1
  v_mfma_f32_16x16x32_bf16 v[44:47], v[52:55], v[204:207], v[44:47]
  s_waitcnt vmcnt(5)
  buffer_load_dwordx4 v[232:235], v3, s[44:47], s14 offen offset:2048 nt
  v_and_b32_dpp v48, v67, v32 row_newbcast:0 row_mask:0xf bank_mask:0xf
  v_and_b32_dpp v49, v67, v33 row_newbcast:0 row_mask:0xf bank_mask:0xf
  v_and_b32_dpp v50, v67, v34 row_newbcast:0 row_mask:0xf bank_mask:0xf
  v_and_b32_dpp v51, v67, v35 row_newbcast:0 row_mask:0xf bank_mask:0xf
  s_nop 1
  v_mfma_f32_16x16x32_bf16 v[44:47], v[48:51], v[96:99], v[44:47]
  s_waitcnt vmcnt(5)
  buffer_load_dwordx4 v[236:239], v3, s[44:47], s14 offen offset:3072 nt
  v_and_b32_dpp v52, v67, v32 row_newbcast:4 row_mask:0xf bank_mask:0xf
  v_and_b32_dpp v53, v67, v33 row_newbcast:4 row_mask:0xf bank_mask:0xf
  v_and_b32_dpp v54, v67, v34 row_newbcast:4 row_mask:0xf bank_mask:0xf
  v_and_b32_dpp v55, v67, v35 row_newbcast:4 row_mask:0xf bank_mask:0xf
  s_nop 1
  v_mfma_f32_16x16x32_bf16 v[44:47], v[52:55], v[100:103], v[44:47]
  s_waitcnt vmcnt(5)
  s_mov_b32 s14, 278528
  buffer_load_dwordx4 v[144:147], v3, s[44:47], s14 offen offset:0 nt
  ds_read_b32 v62, v63 offset:24
  v_and_b32_dpp v48, v67, v32 row_newbcast:8 row_mask:0xf bank_mask:0xf
  v_and_b32_dpp v49, v67, v33 row_newbcast:8 row_mask:0xf bank_mask:0xf
  v_and_b32_dpp v50, v67, v34 row_newbcast:8 row_mask:0xf bank_mask:0xf
  v_and_b32_dpp v51, v67, v35 row_newbcast:8 row_mask:0xf bank_mask:0xf
  s_nop 1
  v_mfma_f32_16x16x32_bf16 v[44:47], v[48:51], v[104:107], v[44:47]
  s_waitcnt vmcnt(5)
  buffer_load_dwordx4 v[148:151], v3, s[44:47], s14 offen offset:1024 nt
  v_and_b32_dpp v52, v67, v32 row_newbcast:12 row_mask:0xf bank_mask:0xf
  v_and_b32_dpp v53, v67, v33 row_newbcast:12 row_mask:0xf bank_mask:0xf
  v_and_b32_dpp v54, v67, v34 row_newbcast:12 row_mask:0xf bank_mask:0xf
  v_and_b32_dpp v55, v67, v35 row_newbcast:12 row_mask:0xf bank_mask:0xf
  s_nop 1
  v_mfma_f32_16x16x32_bf16 v[44:47], v[52:55], v[108:111], v[44:47]
  s_waitcnt vmcnt(5)
  buffer_load_dwordx4 v[152:155], v3, s[44:47], s14 offen offset:2048 nt
  s_waitcnt lgkmcnt(0)
  v_readfirstlane_b32 s100, v62
  v_mov_b32 v60, 0
  global_load_dword v61, v60, s[36:37] offset:128
  v_and_b32_dpp v48, v68, v32 row_newbcast:0 row_mask:0xf bank_mask:0xf
  v_and_b32_dpp v49, v68, v33 row_newbcast:0 row_mask:0xf bank_mask:0xf
  v_and_b32_dpp v50, v68, v34 row_newbcast:0 row_mask:0xf bank_mask:0xf
  v_and_b32_dpp v51, v68, v35 row_newbcast:0 row_mask:0xf bank_mask:0xf
  s_nop 1
  v_mfma_f32_16x16x32_bf16 v[44:47], v[48:51], v[224:227], v[44:47]
  s_cmp_gt_u32 s100, 13
  s_cbranch_scc1 L_lad_4
  s_cmp_gt_u32 s100, 5
  s_cbranch_scc1 L_lad_5
  s_waitcnt vmcnt(4)
L_lad_5:
  s_waitcnt vmcnt(5)
L_lad_4:
  s_waitcnt vmcnt(6)
  buffer_load_dwordx4 v[156:159], v3, s[44:47], s14 offen offset:3072 nt
  v_and_b32_dpp v52, v68, v32 row_newbcast:4 row_mask:0xf bank_mask:0xf
  v_and_b32_dpp v53, v68, v33 row_newbcast:4 row_mask:0xf bank_mask:0xf
  v_and_b32_dpp v54, v68, v34 row_newbcast:4 row_mask:0xf bank_mask:0xf
  v_and_b32_dpp v55, v68, v35 row_newbcast:4 row_mask:0xf bank_mask:0xf
  s_nop 1
  v_mfma_f32_16x16x32_bf16 v[44:47], v[52:55], v[228:231], v[44:47]
  s_cmp_gt_u32 s100, 14
  s_cbranch_scc1 L_lad_6
  s_cmp_gt_u32 s100, 6
  s_cbranch_scc1 L_lad_7
  s_waitcnt vmcnt(4)
L_lad_7:
  s_waitcnt vmcnt(5)
L_lad_6:
  s_waitcnt vmcnt(6)
  s_mov_b32 s14, 393216
  buffer_load_dwordx4 v[208:211], v3, s[44:47], s14 offen offset:0 nt
  v_and_b32_dpp v48, v68, v32 row_newbcast:8 row_mask:0xf bank_mask:0xf
  v_and_b32_dpp v49, v68, v33 row_newbcast:8 row_mask:0xf bank_mask:0xf
  v_and_b32_dpp v50, v68, v34 row_newbcast:8 row_mask:0xf bank_mask:0xf
  v_and_b32_dpp v51, v68, v35 row_newbcast:8 row_mask:0xf bank_mask:0xf
  s_nop 1
  v_mfma_f32_16x16x32_bf16 v[44:47], v[48:51], v[232:235], v[44:47]
  s_cmp_gt_u32 s100, 14
  s_cbranch_scc1 L_lad_8
  s_cmp_gt_u32 s100, 6
  s_cbranch_scc1 L_lad_9
  s_waitcnt vmcnt(4)
L_lad_9:
  s_waitcnt vmcnt(5)
L_lad_8:
  s_waitcnt vmcnt(6)
  buffer_load_dwordx4 v[212:215], v3, s[44:47], s14 offen offset:1024 nt
  ds_read_b32 v62, v63 offset:24
  v_and_b32_dpp v52, v68, v32 row_newbcast:12 row_mask:0xf bank_mask:0xf
  v_and_b32_dpp v53, v68, v33 row_newbcast:12 row_mask:0xf bank_mask:0xf
  v_and_b32_dpp v54, v68, v34 row_newbcast:12 row_mask:0xf bank_mask:0xf
  v_and_b32_dpp v55, v68, v35 row_newbcast:12 row_mask:0xf bank_mask:0xf
  s_nop 1
  v_mfma_f32_16x16x32_bf16 v[44:47], v[52:55], v[236:239], v[44:47]
  s_cmp_gt_u32 s100, 14
  s_cbranch_scc1 L_lad_10
  s_cmp_gt_u32 s100, 6
  s_cbranch_scc1 L_lad_11
  s_waitcnt vmcnt(4)
L_lad_11:
  s_waitcnt vmcnt(5)
L_lad_10:
  s_waitcnt vmcnt(6)
  buffer_load_dwordx4 v[216:219], v3, s[44:47], s14 offen offset:2048 nt
  v_and_b32_dpp v48, v69, v32 row_newbcast:0 row_mask:0xf bank_mask:0xf
  v_and_b32_dpp v49, v69, v33 row_newbcast:0 row_mask:0xf bank_mask:0xf
  v_and_b32_dpp v50, v69, v34 row_newbcast:0 row_mask:0xf bank_mask:0xf
  v_and_b32_dpp v51, v69, v35 row_newbcast:0 row_mask:0xf bank_mask:0xf
  s_nop 1
  v_mfma_f32_16x16x32_bf16 v[44:47], v[48:51], v[144:147], v[44:47]
  s_cmp_gt_u32 s100, 14
  s_cbranch_scc1 L_lad_12
  s_cmp_gt_u32 s100, 6
  s_cbranch_scc1 L_lad_13
  s_waitcnt vmcnt(4)
L_lad_13:
  s_waitcnt vmcnt(5)
L_lad_12:
  s_waitcnt vmcnt(6)
  buffer_load_dwordx4 v[220:223], v3, s[44:47], s14 offen offset:3072 nt
  s_waitcnt lgkmcnt(0)
  v_readfirstlane_b32 s100, v62
  v_and_b32_dpp v52, v69, v32 row_newbcast:4 row_mask:0xf bank_mask:0xf
  v_and_b32_dpp v53, v69, v33 row_newbcast:4 row_mask:0xf bank_mask:0xf
  v_and_b32_dpp v54, v69, v34 row_newbcast:4 row_mask:0xf bank_mask:0xf
  v_and_b32_dpp v55, v69, v35 row_newbcast:4 row_mask:0xf bank_mask:0xf
  s_nop 1
  v_mfma_f32_16x16x32_bf16 v[44:47], v[52:55], v[148:151], v[44:47]
  s_cmp_gt_u32 s100, 7
  s_cbranch_scc1 L_lad_14
  s_waitcnt vmcnt(4)
L_lad_14:
  s_waitcnt vmcnt(5)
  s_mov_b32 s14, 409600
  buffer_load_dwordx4 v[112:115], v3, s[44:47], s14 offen offset:0 nt
  v_and_b32_dpp v48, v69, v32 row_newbcast:8 row_mask:0xf bank_mask:0xf
  v_and_b32_dpp v49, v69, v33 row_newbcast:8 row_mask:0xf bank_mask:0xf
  v_and_b32_dpp v50, v69, v34 row_newbcast:8 row_mask:0xf bank_mask:0xf
  v_and_b32_dpp v51, v69, v35 row_newbcast:8 row_mask:0xf bank_mask:0xf
  s_nop 1
  v_mfma_f32_16x16x32_bf16 v[44:47], v[48:51], v[152:155], v[44:47]
  s_mov_b32 s11, 0
L_cntspin_16:
  v_cmp_ne_u32 vcc, 0, v61
  s_cbranch_vccnz L_cntok_15
  s_add_u32 s11, s11, 1
  s_cmp_ge_u32 s11, 16384
  s_cbranch_scc1 L_cntok_15
  global_load_dword v61, v60, s[36:37] offset:128 sc1
  s_waitcnt vmcnt(0)
  s_branch L_cntspin_16
L_cntok_15:
  v_readfirstlane_b32 s10, v61
  s_lshr_b32 s69, s10, s9
  s_and_b32 s69, s69, 1
  s_sub_u32 s11, s69, 1
  s_xor_b32 s10, s10, s11
  s_bfm_b32 s11, s9, 0
  s_and_b32 s10, s10, s11
  s_bcnt1_i32_b32 s70, s10
  s_and_b32 s75, s7, 7
  s_mul_i32 s75, s75, 288
  s_xor_b32 s75, s75, 32
  s_and_b32 s10, s7, 3
  s_lshl_b32 s10, s10, 3
  s_add_u32 s75, s75, s10
  s_lshr_b32 s10, s7, 3
  s_add_u32 s75, s75, s10
  s_lshl_b32 s75, s75, 10
  s_add_u32 s75, s75, 2097152
  s_lshl_b32 s10, s5, 8
  s_add_u32 s10, s10, s75
  s_lshl_b32 s11, s3, 6
  s_add_u32 s10, s10, s11
  v_cmp_gt_u32 vcc, 4, v1
  v_mov_b32 v4, 1073741824
  v_lshlrev_b32 v5, 4, v1
  v_cndmask_b32 v15, v4, v5, vcc
  v_mov_b32 v4, v13
  v_mov_b32 v5, v14
  v_mov_b32 v6, v13
  v_mov_b32 v7, v14
  buffer_store_dwordx4 v[4:7], v15, s[56:59], s10 offen sc1
  s_cmp_gt_u32 s100, 7
  s_cbranch_scc1 L_lad_17
  s_waitcnt vmcnt(4)
L_lad_17:
  s_waitcnt vmcnt(5)
  buffer_load_dwordx4 v[116:119], v3, s[44:47], s14 offen offset:1024 nt
  v_and_b32_dpp v52, v69, v32 row_newbcast:12 row_mask:0xf bank_mask:0xf
  v_and_b32_dpp v53, v69, v33 row_newbcast:12 row_mask:0xf bank_mask:0xf
  v_and_b32_dpp v54, v69, v34 row_newbcast:12 row_mask:0xf bank_mask:0xf
  v_and_b32_dpp v55, v69, v35 row_newbcast:12 row_mask:0xf bank_mask:0xf
  s_nop 1
  v_mfma_f32_16x16x32_bf16 v[44:47], v[52:55], v[156:159], v[44:47]
  s_cmp_gt_u32 s100, 7
  s_cbranch_scc1 L_lad_18
  s_waitcnt vmcnt(4)
L_lad_18:
  s_waitcnt vmcnt(5)
  buffer_load_dwordx4 v[120:123], v3, s[44:47], s14 offen offset:2048 nt
  ds_read_b32 v62, v63 offset:24
  v_and_b32_dpp v48, v70, v32 row_newbcast:0 row_mask:0xf bank_mask:0xf
  v_and_b32_dpp v49, v70, v33 row_newbcast:0 row_mask:0xf bank_mask:0xf
  v_and_b32_dpp v50, v70, v34 row_newbcast:0 row_mask:0xf bank_mask:0xf
  v_and_b32_dpp v51, v70, v35 row_newbcast:0 row_mask:0xf bank_mask:0xf
  s_nop 1
  v_mfma_f32_16x16x32_bf16 v[44:47], v[48:51], v[208:211], v[44:47]
  s_cmp_gt_u32 s100, 7
  s_cbranch_scc1 L_lad_19
  s_waitcnt vmcnt(4)
L_lad_19:
  s_waitcnt vmcnt(5)
  buffer_load_dwordx4 v[124:127], v3, s[44:47], s14 offen offset:3072 nt
  v_and_b32_dpp v52, v70, v32 row_newbcast:4 row_mask:0xf bank_mask:0xf
  v_and_b32_dpp v53, v70, v33 row_newbcast:4 row_mask:0xf bank_mask:0xf
  v_and_b32_dpp v54, v70, v34 row_newbcast:4 row_mask:0xf bank_mask:0xf
  v_and_b32_dpp v55, v70, v35 row_newbcast:4 row_mask:0xf bank_mask:0xf
  s_nop 1
  v_mfma_f32_16x16x32_bf16 v[44:47], v[52:55], v[212:215], v[44:47]
  s_cmp_gt_u32 s100, 8
  s_cbranch_scc1 L_lad_20
  s_cmp_gt_u32 s100, 0
  s_cbranch_scc1 L_lad_21
  s_waitcnt vmcnt(4)
L_lad_21:
  s_waitcnt vmcnt(5)
L_lad_20:
  s_mov_b32 s14, 524288
  buffer_load_dwordx4 v[128:131], v3, s[44:47], s14 offen offset:0 nt
  s_waitcnt lgkmcnt(0)
  v_readfirstlane_b32 s100, v62
  s_cmp_gt_u32 s100, 8
  s_cbranch_scc1 L_lad_22
  s_cmp_gt_u32 s100, 0
  s_cbranch_scc1 L_lad_23
  s_waitcnt vmcnt(4)
L_lad_23:
  s_waitcnt vmcnt(5)
L_lad_22:
  s_waitcnt vmcnt(6)
  buffer_load_dwordx4 v[132:135], v3, s[44:47], s14 offen offset:1024 nt
  v_and_b32_dpp v48, v70, v32 row_newbcast:8 row_mask:0xf bank_mask:0xf
  v_and_b32_dpp v49, v70, v33 row_newbcast:8 row_mask:0xf bank_mask:0xf
  v_and_b32_dpp v50, v70, v34 row_newbcast:8 row_mask:0xf bank_mask:0xf
  v_and_b32_dpp v51, v70, v35 row_newbcast:8 row_mask:0xf bank_mask:0xf
  s_nop 1
  v_mfma_f32_16x16x32_bf16 v[44:47], v[48:51], v[216:219], v[44:47]
  s_cmp_gt_u32 s100, 8
  s_cbranch_scc1 L_lad_24
  s_cmp_gt_u32 s100, 0
  s_cbranch_scc1 L_lad_25
  s_waitcnt vmcnt(4)
L_lad_25:
  s_waitcnt vmcnt(5)
L_lad_24:
  s_waitcnt vmcnt(6)
  buffer_load_dwordx4 v[136:139], v3, s[44:47], s14 offen offset:2048 nt
  v_and_b32_dpp v52, v70, v32 row_newbcast:12 row_mask:0xf bank_mask:0xf
  v_and_b32_dpp v53, v70, v33 row_newbcast:12 row_mask:0xf bank_mask:0xf
  v_and_b32_dpp v54, v70, v34 row_newbcast:12 row_mask:0xf bank_mask:0xf
  v_and_b32_dpp v55, v70, v35 row_newbcast:12 row_mask:0xf bank_mask:0xf
  s_nop 1
  v_mfma_f32_16x16x32_bf16 v[44:47], v[52:55], v[220:223], v[44:47]
  s_cmp_gt_u32 s100, 8
  s_cbranch_scc1 L_lad_26
  s_cmp_gt_u32 s100, 0
  s_cbranch_scc1 L_lad_27
  s_waitcnt vmcnt(4)
L_lad_27:
  s_waitcnt vmcnt(5)
L_lad_26:
  s_waitcnt vmcnt(6)
  buffer_load_dwordx4 v[140:143], v3, s[44:47], s14 offen offset:3072 nt
  ds_read_b32 v62, v63 offset:24
  v_and_b32_dpp v48, v71, v32 row_newbcast:0 row_mask:0xf bank_mask:0xf
  v_and_b32_dpp v49, v71, v33 row_newbcast:0 row_mask:0xf bank_mask:0xf
  v_and_b32_dpp v50, v71, v34 row_newbcast:0 row_mask:0xf bank_mask:0xf
  v_and_b32_dpp v51, v71, v35 row_newbcast:0 row_mask:0xf bank_mask:0xf
  s_nop 1
  v_mfma_f32_16x16x32_bf16 v[44:47], v[48:51], v[112:115], v[44:47]
  s_cmp_gt_u32 s100, 9
  s_cbranch_scc1 L_lad_28
  s_cmp_gt_u32 s100, 1
  s_cbranch_scc1 L_lad_29
  s_waitcnt vmcnt(4)
L_lad_29:
  s_waitcnt vmcnt(5)
L_lad_28:
  s_waitcnt vmcnt(6)
  s_mov_b32 s14, 540672
  buffer_load_dwordx4 v[240:243], v3, s[44:47], s14 offen offset:0 nt
  v_and_b32_dpp v52, v71, v32 row_newbcast:4 row_mask:0xf bank_mask:0xf
  v_and_b32_dpp v53, v71, v33 row_newbcast:4 row_mask:0xf bank_mask:0xf
  v_and_b32_dpp v54, v71, v34 row_newbcast:4 row_mask:0xf bank_mask:0xf
  v_and_b32_dpp v55, v71, v35 row_newbcast:4 row_mask:0xf bank_mask:0xf
  s_nop 1
  v_mfma_f32_16x16x32_bf16 v[44:47], v[52:55], v[116:119], v[44:47]
  s_cmp_gt_u32 s100, 9
  s_cbranch_scc1 L_lad_30
  s_cmp_gt_u32 s100, 1
  s_cbranch_scc1 L_lad_31
  s_waitcnt vmcnt(4)
L_lad_31:
  s_waitcnt vmcnt(5)
L_lad_30:
  s_waitcnt vmcnt(6)
  buffer_load_dwordx4 v[244:247], v3, s[44:47], s14 offen offset:1024 nt
  s_waitcnt lgkmcnt(0)
  v_readfirstlane_b32 s100, v62
  v_and_b32_dpp v48, v71, v32 row_newbcast:8 row_mask:0xf bank_mask:0xf
  v_and_b32_dpp v49, v71, v33 row_newbcast:8 row_mask:0xf bank_mask:0xf
  v_and_b32_dpp v50, v71, v34 row_newbcast:8 row_mask:0xf bank_mask:0xf
  v_and_b32_dpp v51, v71, v35 row_newbcast:8 row_mask:0xf bank_mask:0xf
  s_nop 1
  v_mfma_f32_16x16x32_bf16 v[44:47], v[48:51], v[120:123], v[44:47]
  s_cmp_gt_u32 s100, 9
  s_cbranch_scc1 L_lad_32
  s_cmp_gt_u32 s100, 1
  s_cbranch_scc1 L_lad_33
  s_waitcnt vmcnt(4)
L_lad_33:
  s_waitcnt vmcnt(5)
L_lad_32:
  s_waitcnt vmcnt(6)
  buffer_load_dwordx4 v[248:251], v3, s[44:47], s14 offen offset:2048 nt
  v_and_b32_dpp v52, v71, v32 row_newbcast:12 row_mask:0xf bank_mask:0xf
  v_and_b32_dpp v53, v71, v33 row_newbcast:12 row_mask:0xf bank_mask:0xf
  v_and_b32_dpp v54, v71, v34 row_newbcast:12 row_mask:0xf bank_mask:0xf
  v_and_b32_dpp v55, v71, v35 row_newbcast:12 row_mask:0xf bank_mask:0xf
  s_nop 1
  v_mfma_f32_16x16x32_bf16 v[44:47], v[52:55], v[124:127], v[44:47]
  s_cmp_gt_u32 s100, 9
  s_cbranch_scc1 L_lad_34
  s_cmp_gt_u32 s100, 1
  s_cbranch_scc1 L_lad_35
  s_waitcnt vmcnt(4)
L_lad_35:
  s_waitcnt vmcnt(5)
L_lad_34:
  s_waitcnt vmcnt(6)
  buffer_load_dwordx4 v[252:255], v3, s[44:47], s14 offen offset:3072 nt
  v_and_b32_dpp v48, v72, v32 row_newbcast:0 row_mask:0xf bank_mask:0xf
  v_and_b32_dpp v49, v72, v33 row_newbcast:0 row_mask:0xf bank_mask:0xf
  v_and_b32_dpp v50, v72, v34 row_newbcast:0 row_mask:0xf bank_mask:0xf
  v_and_b32_dpp v51, v72, v35 row_newbcast:0 row_mask:0xf bank_mask:0xf
  s_nop 1
  v_mfma_f32_16x16x32_bf16 v[44:47], v[48:51], v[128:131], v[44:47]
  s_cmp_gt_u32 s100, 10
  s_cbranch_scc1 L_lad_36
  s_cmp_gt_u32 s100, 2
  s_cbranch_scc1 L_lad_37
  s_waitcnt vmcnt(4)
L_lad_37:
  s_waitcnt vmcnt(5)
L_lad_36:
  s_waitcnt vmcnt(6)
  s_mov_b32 s14, 655360
  buffer_load_dwordx4 v[160:163], v3, s[44:47], s14 offen offset:0 nt
  v_and_b32_dpp v52, v72, v32 row_newbcast:4 row_mask:0xf bank_mask:0xf
  v_and_b32_dpp v53, v72, v33 row_newbcast:4 row_mask:0xf bank_mask:0xf
  v_and_b32_dpp v54, v72, v34 row_newbcast:4 row_mask:0xf bank_mask:0xf
  v_and_b32_dpp v55, v72, v35 row_newbcast:4 row_mask:0xf bank_mask:0xf
  s_nop 1
  v_mfma_f32_16x16x32_bf16 v[44:47], v[52:55], v[132:135], v[44:47]
  s_cmp_gt_u32 s100, 10
  s_cbranch_scc1 L_lad_38
  s_cmp_gt_u32 s100, 2
  s_cbranch_scc1 L_lad_39
  s_waitcnt vmcnt(4)
L_lad_39:
  s_waitcnt vmcnt(5)
L_lad_38:
  s_waitcnt vmcnt(6)
  buffer_load_dwordx4 v[164:167], v3, s[44:47], s14 offen offset:1024 nt
  ds_read_b32 v62, v63 offset:24
  v_and_b32_dpp v48, v72, v32 row_newbcast:8 row_mask:0xf bank_mask:0xf
  v_and_b32_dpp v49, v72, v33 row_newbcast:8 row_mask:0xf bank_mask:0xf
  v_and_b32_dpp v50, v72, v34 row_newbcast:8 row_mask:0xf bank_mask:0xf
  v_and_b32_dpp v51, v72, v35 row_newbcast:8 row_mask:0xf bank_mask:0xf
  s_nop 1
  v_mfma_f32_16x16x32_bf16 v[44:47], v[48:51], v[136:139], v[44:47]
  s_cmp_gt_u32 s100, 10
  s_cbranch_scc1 L_lad_40
  s_cmp_gt_u32 s100, 2
  s_cbranch_scc1 L_lad_41
  s_waitcnt vmcnt(4)
L_lad_41:
  s_waitcnt vmcnt(5)
L_lad_40:
  s_waitcnt vmcnt(6)
  buffer_load_dwordx4 v[168:171], v3, s[44:47], s14 offen offset:2048 nt
  v_and_b32_dpp v52, v72, v32 row_newbcast:12 row_mask:0xf bank_mask:0xf
  v_and_b32_dpp v53, v72, v33 row_newbcast:12 row_mask:0xf bank_mask:0xf
  v_and_b32_dpp v54, v72, v34 row_newbcast:12 row_mask:0xf bank_mask:0xf
  v_and_b32_dpp v55, v72, v35 row_newbcast:12 row_mask:0xf bank_mask:0xf
  s_nop 1
  v_mfma_f32_16x16x32_bf16 v[44:47], v[52:55], v[140:143], v[44:47]
  s_cmp_gt_u32 s100, 10
  s_cbranch_scc1 L_lad_42
  s_cmp_gt_u32 s100, 2
  s_cbranch_scc1 L_lad_43
  s_waitcnt vmcnt(4)
L_lad_43:
  s_waitcnt vmcnt(5)
L_lad_42:
  s_waitcnt vmcnt(6)
  buffer_load_dwordx4 v[172:175], v3, s[44:47], s14 offen offset:3072 nt
  s_waitcnt lgkmcnt(0)
  v_readfirstlane_b32 s100, v62
  v_and_b32_dpp v48, v73, v32 row_newbcast:0 row_mask:0xf bank_mask:0xf
  v_and_b32_dpp v49, v73, v33 row_newbcast:0 row_mask:0xf bank_mask:0xf
  v_and_b32_dpp v50, v73, v34 row_newbcast:0 row_mask:0xf bank_mask:0xf
  v_and_b32_dpp v51, v73, v35 row_newbcast:0 row_mask:0xf bank_mask:0xf
  s_nop 1
  v_mfma_f32_16x16x32_bf16 v[44:47], v[48:51], v[240:243], v[44:47]
  s_cmp_gt_u32 s100, 11
  s_cbranch_scc1 L_lad_44
  s_cmp_gt_u32 s100, 3
  s_cbranch_scc1 L_lad_45
  s_waitcnt vmcnt(4)
L_lad_45:
  s_waitcnt vmcnt(5)
L_lad_44:
  s_waitcnt vmcnt(6)
  s_mov_b32 s14, 671744
  buffer_load_dwordx4 v[176:179], v3, s[44:47], s14 offen offset:0 nt
  v_and_b32_dpp v52, v73, v32 row_newbcast:4 row_mask:0xf bank_mask:0xf
  v_and_b32_dpp v53, v73, v33 row_newbcast:4 row_mask:0xf bank_mask:0xf
  v_and_b32_dpp v54, v73, v34 row_newbcast:4 row_mask:0xf bank_mask:0xf
  v_and_b32_dpp v55, v73, v35 row_newbcast:4 row_mask:0xf bank_mask:0xf
  s_nop 1
  v_mfma_f32_16x16x32_bf16 v[44:47], v[52:55], v[244:247], v[44:47]
  s_cmp_gt_u32 s100, 11
  s_cbranch_scc1 L_lad_46
  s_cmp_gt_u32 s100, 3
  s_cbranch_scc1 L_lad_47
  s_waitcnt vmcnt(4)
L_lad_47:
  s_waitcnt vmcnt(5)
L_lad_46:
  s_waitcnt vmcnt(6)
  buffer_load_dwordx4 v[180:183], v3, s[44:47], s14 offen offset:1024 nt
  v_and_b32_dpp v48, v73, v32 row_newbcast:8 row_mask:0xf bank_mask:0xf
  v_and_b32_dpp v49, v73, v33 row_newbcast:8 row_mask:0xf bank_mask:0xf
  v_and_b32_dpp v50, v73, v34 row_newbcast:8 row_mask:0xf bank_mask:0xf
  v_and_b32_dpp v51, v73, v35 row_newbcast:8 row_mask:0xf bank_mask:0xf
  s_nop 1
  v_mfma_f32_16x16x32_bf16 v[44:47], v[48:51], v[248:251], v[44:47]
  s_cmp_gt_u32 s100, 11
  s_cbranch_scc1 L_lad_48
  s_cmp_gt_u32 s100, 3
  s_cbranch_scc1 L_lad_49
  s_waitcnt vmcnt(4)
L_lad_49:
  s_waitcnt vmcnt(5)
L_lad_48:
  s_waitcnt vmcnt(6)
  buffer_load_dwordx4 v[184:187], v3, s[44:47], s14 offen offset:2048 nt
  v_and_b32_dpp v52, v73, v32 row_newbcast:12 row_mask:0xf bank_mask:0xf
  v_and_b32_dpp v53, v73, v33 row_newbcast:12 row_mask:0xf bank_mask:0xf
  v_and_b32_dpp v54, v73, v34 row_newbcast:12 row_mask:0xf bank_mask:0xf
  v_and_b32_dpp v55, v73, v35 row_newbcast:12 row_mask:0xf bank_mask:0xf
  s_nop 1
  v_mfma_f32_16x16x32_bf16 v[44:47], v[52:55], v[252:255], v[44:47]
  s_cmp_gt_u32 s100, 11
  s_cbranch_scc1 L_lad_50
  s_cmp_gt_u32 s100, 3
  s_cbranch_scc1 L_lad_51
  s_waitcnt vmcnt(4)
L_lad_51:
  s_waitcnt vmcnt(5)
L_lad_50:
  s_waitcnt vmcnt(6)
  buffer_load_dwordx4 v[188:191], v3, s[44:47], s14 offen offset:3072 nt
  v_and_b32_dpp v48, v74, v32 row_newbcast:0 row_mask:0xf bank_mask:0xf
  v_and_b32_dpp v49, v74, v33 row_newbcast:0 row_mask:0xf bank_mask:0xf
  v_and_b32_dpp v50, v74, v34 row_newbcast:0 row_mask:0xf bank_mask:0xf
  v_and_b32_dpp v51, v74, v35 row_newbcast:0 row_mask:0xf bank_mask:0xf
  s_nop 1
  v_mfma_f32_16x16x32_bf16 v[44:47], v[48:51], v[160:163], v[44:47]
  s_cmp_gt_u32 s100, 12
  s_cbranch_scc1 L_lad_52
  s_cmp_gt_u32 s100, 4
  s_cbranch_scc1 L_lad_53
  s_waitcnt vmcnt(4)
L_lad_53:
  s_waitcnt vmcnt(5)
L_lad_52:
  s_waitcnt vmcnt(6)
  s_mov_b32 s14, 786432
  buffer_load_dwordx4 v[192:195], v3, s[44:47], s14 offen offset:0 nt
  v_and_b32_dpp v52, v74, v32 row_newbcast:4 row_mask:0xf bank_mask:0xf
  v_and_b32_dpp v53, v74, v33 row_newbcast:4 row_mask:0xf bank_mask:0xf
  v_and_b32_dpp v54, v74, v34 row_newbcast:4 row_mask:0xf bank_mask:0xf
  v_and_b32_dpp v55, v74, v35 row_newbcast:4 row_mask:0xf bank_mask:0xf
  s_nop 1
  v_mfma_f32_16x16x32_bf16 v[44:47], v[52:55], v[164:167], v[44:47]
  s_cmp_gt_u32 s100, 12
  s_cbranch_scc1 L_lad_54
  s_cmp_gt_u32 s100, 4
  s_cbranch_scc1 L_lad_55
  s_waitcnt vmcnt(4)
L_lad_55:
  s_waitcnt vmcnt(5)
L_lad_54:
  s_waitcnt vmcnt(6)
  buffer_load_dwordx4 v[196:199], v3, s[44:47], s14 offen offset:1024 nt
  v_and_b32_dpp v48, v74, v32 row_newbcast:8 row_mask:0xf bank_mask:0xf
  v_and_b32_dpp v49, v74, v33 row_newbcast:8 row_mask:0xf bank_mask:0xf
  v_and_b32_dpp v50, v74, v34 row_newbcast:8 row_mask:0xf bank_mask:0xf
  v_and_b32_dpp v51, v74, v35 row_newbcast:8 row_mask:0xf bank_mask:0xf
  s_nop 1
  v_mfma_f32_16x16x32_bf16 v[44:47], v[48:51], v[168:171], v[44:47]
  s_cmp_gt_u32 s100, 12
  s_cbranch_scc1 L_lad_56
  s_cmp_gt_u32 s100, 4
  s_cbranch_scc1 L_lad_57
  s_waitcnt vmcnt(4)
L_lad_57:
  s_waitcnt vmcnt(5)
L_lad_56:
  s_waitcnt vmcnt(6)
  buffer_load_dwordx4 v[200:203], v3, s[44:47], s14 offen offset:2048 nt
  v_and_b32_dpp v52, v74, v32 row_newbcast:12 row_mask:0xf bank_mask:0xf
  v_and_b32_dpp v53, v74, v33 row_newbcast:12 row_mask:0xf bank_mask:0xf
  v_and_b32_dpp v54, v74, v34 row_newbcast:12 row_mask:0xf bank_mask:0xf
  v_and_b32_dpp v55, v74, v35 row_newbcast:12 row_mask:0xf bank_mask:0xf
  s_nop 1
  v_mfma_f32_16x16x32_bf16 v[44:47], v[52:55], v[172:175], v[44:47]
  s_cmp_gt_u32 s100, 12
  s_cbranch_scc1 L_lad_58
  s_cmp_gt_u32 s100, 4
  s_cbranch_scc1 L_lad_59
  s_waitcnt vmcnt(4)
L_lad_59:
  s_waitcnt vmcnt(5)
L_lad_58:
  s_waitcnt vmcnt(6)
  buffer_load_dwordx4 v[204:207], v3, s[44:47], s14 offen offset:3072 nt
  v_and_b32_dpp v48, v75, v32 row_newbcast:0 row_mask:0xf bank_mask:0xf
  v_and_b32_dpp v49, v75, v33 row_newbcast:0 row_mask:0xf bank_mask:0xf
  v_and_b32_dpp v50, v75, v34 row_newbcast:0 row_mask:0xf bank_mask:0xf
  v_and_b32_dpp v51, v75, v35 row_newbcast:0 row_mask:0xf bank_mask:0xf
  s_nop 1
  v_mfma_f32_16x16x32_bf16 v[44:47], v[48:51], v[176:179], v[44:47]
  s_cmp_gt_u32 s100, 13
  s_cbranch_scc1 L_lad_60
  s_cmp_gt_u32 s100, 5
  s_cbranch_scc1 L_lad_61
  s_waitcnt vmcnt(4)
L_lad_61:
  s_waitcnt vmcnt(5)
L_lad_60:
  s_waitcnt vmcnt(6)
  s_mov_b32 s14, 802816
  buffer_load_dwordx4 v[96:99], v3, s[44:47], s14 offen offset:0 nt
  v_and_b32_dpp v52, v75, v32 row_newbcast:4 row_mask:0xf bank_mask:0xf
  v_and_b32_dpp v53, v75, v33 row_newbcast:4 row_mask:0xf bank_mask:0xf
  v_and_b32_dpp v54, v75, v34 row_newbcast:4 row_mask:0xf bank_mask:0xf
  v_and_b32_dpp v55, v75, v35 row_newbcast:4 row_mask:0xf bank_mask:0xf
  s_nop 1
  v_mfma_f32_16x16x32_bf16 v[44:47], v[52:55], v[180:183], v[44:47]
  s_cmp_gt_u32 s100, 13
  s_cbranch_scc1 L_lad_62
  s_cmp_gt_u32 s100, 5
  s_cbranch_scc1 L_lad_63
  s_waitcnt vmcnt(4)
L_lad_63:
  s_waitcnt vmcnt(5)
L_lad_62:
  s_waitcnt vmcnt(6)
  buffer_load_dwordx4 v[100:103], v3, s[44:47], s14 offen offset:1024 nt
  v_and_b32_dpp v48, v75, v32 row_newbcast:8 row_mask:0xf bank_mask:0xf
  v_and_b32_dpp v49, v75, v33 row_newbcast:8 row_mask:0xf bank_mask:0xf
  v_and_b32_dpp v50, v75, v34 row_newbcast:8 row_mask:0xf bank_mask:0xf
  v_and_b32_dpp v51, v75, v35 row_newbcast:8 row_mask:0xf bank_mask:0xf
  s_nop 1
  v_mfma_f32_16x16x32_bf16 v[44:47], v[48:51], v[184:187], v[44:47]
  s_cmp_gt_u32 s100, 13
  s_cbranch_scc1 L_lad_64
  s_cmp_gt_u32 s100, 5
  s_cbranch_scc1 L_lad_65
  s_waitcnt vmcnt(4)
L_lad_65:
  s_waitcnt vmcnt(5)
L_lad_64:
  s_waitcnt vmcnt(6)
  buffer_load_dwordx4 v[104:107], v3, s[44:47], s14 offen offset:2048 nt
  v_and_b32_dpp v52, v75, v32 row_newbcast:12 row_mask:0xf bank_mask:0xf
  v_and_b32_dpp v53, v75, v33 row_newbcast:12 row_mask:0xf bank_mask:0xf
  v_and_b32_dpp v54, v75, v34 row_newbcast:12 row_mask:0xf bank_mask:0xf
  v_and_b32_dpp v55, v75, v35 row_newbcast:12 row_mask:0xf bank_mask:0xf
  s_nop 1
  v_mfma_f32_16x16x32_bf16 v[44:47], v[52:55], v[188:191], v[44:47]
  s_cmp_gt_u32 s100, 13
  s_cbranch_scc1 L_lad_66
  s_cmp_gt_u32 s100, 5
  s_cbranch_scc1 L_lad_67
  s_waitcnt vmcnt(4)
L_lad_67:
  s_waitcnt vmcnt(5)
L_lad_66:
  s_waitcnt vmcnt(6)
  buffer_load_dwordx4 v[108:111], v3, s[44:47], s14 offen offset:3072 nt
  v_and_b32_dpp v48, v76, v32 row_newbcast:0 row_mask:0xf bank_mask:0xf
  v_and_b32_dpp v49, v76, v33 row_newbcast:0 row_mask:0xf bank_mask:0xf
  v_and_b32_dpp v50, v76, v34 row_newbcast:0 row_mask:0xf bank_mask:0xf
  v_and_b32_dpp v51, v76, v35 row_newbcast:0 row_mask:0xf bank_mask:0xf
  s_nop 1
  v_mfma_f32_16x16x32_bf16 v[44:47], v[48:51], v[192:195], v[44:47]
  s_cmp_gt_u32 s100, 14
  s_cbranch_scc1 L_lad_68
  s_cmp_gt_u32 s100, 6
  s_cbranch_scc1 L_lad_69
  s_waitcnt vmcnt(4)
L_lad_69:
  s_waitcnt vmcnt(5)
L_lad_68:
  s_waitcnt vmcnt(6)
  s_mov_b32 s14, 917504
  buffer_load_dwordx4 v[224:227], v3, s[44:47], s14 offen offset:0 nt
  v_and_b32_dpp v52, v76, v32 row_newbcast:4 row_mask:0xf bank_mask:0xf
  v_and_b32_dpp v53, v76, v33 row_newbcast:4 row_mask:0xf bank_mask:0xf
  v_and_b32_dpp v54, v76, v34 row_newbcast:4 row_mask:0xf bank_mask:0xf
  v_and_b32_dpp v55, v76, v35 row_newbcast:4 row_mask:0xf bank_mask:0xf
  s_nop 1
  v_mfma_f32_16x16x32_bf16 v[44:47], v[52:55], v[196:199], v[44:47]
  s_cmp_gt_u32 s100, 14
  s_cbranch_scc1 L_lad_70
  s_cmp_gt_u32 s100, 6
  s_cbranch_scc1 L_lad_71
  s_waitcnt vmcnt(4)
L_lad_71:
  s_waitcnt vmcnt(5)
L_lad_70:
  s_waitcnt vmcnt(6)
  buffer_load_dwordx4 v[228:231], v3, s[44:47], s14 offen offset:1024 nt
  ds_add_u32 v63, v0 offset:20
L_acw_72:
  v_and_b32_dpp v48, v76, v32 row_newbcast:8 row_mask:0xf bank_mask:0xf
  v_and_b32_dpp v49, v76, v33 row_newbcast:8 row_mask:0xf bank_mask:0xf
  v_and_b32_dpp v50, v76, v34 row_newbcast:8 row_mask:0xf bank_mask:0xf
  v_and_b32_dpp v51, v76, v35 row_newbcast:8 row_mask:0xf bank_mask:0xf
  s_nop 1
  v_mfma_f32_16x16x32_bf16 v[44:47], v[48:51], v[200:203], v[44:47]
  s_cmp_gt_u32 s100, 14
  s_cbranch_scc1 L_lad_73
  s_cmp_gt_u32 s100, 6
  s_cbranch_scc1 L_lad_74
  s_waitcnt vmcnt(4)
L_lad_74:
  s_waitcnt vmcnt(5)
L_lad_73:
  s_waitcnt vmcnt(6)
  buffer_load_dwordx4 v[232:235], v3, s[44:47], s14 offen offset:2048 nt
  v_and_b32_dpp v52, v76, v32 row_newbcast:12 row_mask:0xf bank_mask:0xf
  v_and_b32_dpp v53, v76, v33 row_newbcast:12 row_mask:0xf bank_mask:0xf
  v_and_b32_dpp v54, v76, v34 row_newbcast:12 row_mask:0xf bank_mask:0xf
  v_and_b32_dpp v55, v76, v35 row_newbcast:12 row_mask:0xf bank_mask:0xf
  s_nop 1
  v_mfma_f32_16x16x32_bf16 v[44:47], v[52:55], v[204:207], v[44:47]
  s_cmp_gt_u32 s100, 14
  s_cbranch_scc1 L_lad_75
  s_cmp_gt_u32 s100, 6
  s_cbranch_scc1 L_lad_76
  s_waitcnt vmcnt(4)
L_lad_76:
  s_waitcnt vmcnt(5)
L_lad_75:
  s_waitcnt vmcnt(6)
  buffer_load_dwordx4 v[236:239], v3, s[44:47], s14 offen offset:3072 nt
  v_and_b32_dpp v48, v77, v32 row_newbcast:0 row_mask:0xf bank_mask:0xf
  v_and_b32_dpp v49, v77, v33 row_newbcast:0 row_mask:0xf bank_mask:0xf
  v_and_b32_dpp v50, v77, v34 row_newbcast:0 row_mask:0xf bank_mask:0xf
  v_and_b32_dpp v51, v77, v35 row_newbcast:0 row_mask:0xf bank_mask:0xf
  s_nop 1
  v_mfma_f32_16x16x32_bf16 v[44:47], v[48:51], v[96:99], v[44:47]
  s_cmp_gt_u32 s100, 7
  s_cbranch_scc1 L_lad_77
  s_waitcnt vmcnt(4)
L_lad_77:
  s_waitcnt vmcnt(5)
  s_mov_b32 s14, 933888
  buffer_load_dwordx4 v[144:147], v3, s[44:47], s14 offen offset:0 nt
  v_and_b32_dpp v52, v77, v32 row_newbcast:4 row_mask:0xf bank_mask:0xf
  v_and_b32_dpp v53, v77, v33 row_newbcast:4 row_mask:0xf bank_mask:0xf
  v_and_b32_dpp v54, v77, v34 row_newbcast:4 row_mask:0xf bank_mask:0xf
  v_and_b32_dpp v55, v77, v35 row_newbcast:4 row_mask:0xf bank_mask:0xf
  s_nop 1
  v_mfma_f32_16x16x32_bf16 v[44:47], v[52:55], v[100:103], v[44:47]
  v_and_b32_dpp v48, v77, v32 row_newbcast:8 row_mask:0xf bank_mask:0xf
  v_and_b32_dpp v49, v77, v33 row_newbcast:8 row_mask:0xf bank_mask:0xf
  v_and_b32_dpp v50, v77, v34 row_newbcast:8 row_mask:0xf bank_mask:0xf
  v_and_b32_dpp v51, v77, v35 row_newbcast:8 row_mask:0xf bank_mask:0xf
  s_nop 1
  v_mfma_f32_16x16x32_bf16 v[44:47], v[48:51], v[104:107], v[44:47]
  s_cmp_gt_u32 s100, 7
  s_cbranch_scc1 L_lad_78
  s_waitcnt vmcnt(4)
L_lad_78:
  s_waitcnt vmcnt(5)
  buffer_load_dwordx4 v[148:151], v3, s[44:47], s14 offen offset:1024 nt
  v_and_b32_dpp v52, v77, v32 row_newbcast:12 row_mask:0xf bank_mask:0xf
  v_and_b32_dpp v53, v77, v33 row_newbcast:12 row_mask:0xf bank_mask:0xf
  v_and_b32_dpp v54, v77, v34 row_newbcast:12 row_mask:0xf bank_mask:0xf
  v_and_b32_dpp v55, v77, v35 row_newbcast:12 row_mask:0xf bank_mask:0xf
  s_nop 1
  v_mfma_f32_16x16x32_bf16 v[44:47], v[52:55], v[108:111], v[44:47]
  s_cmp_gt_u32 s100, 7
  s_cbranch_scc1 L_lad_79
  s_waitcnt vmcnt(4)
L_lad_79:
  s_waitcnt vmcnt(5)
  buffer_load_dwordx4 v[152:155], v3, s[44:47], s14 offen offset:2048 nt
  v_and_b32_dpp v48, v78, v32 row_newbcast:0 row_mask:0xf bank_mask:0xf
  v_and_b32_dpp v49, v78, v33 row_newbcast:0 row_mask:0xf bank_mask:0xf
  v_and_b32_dpp v50, v78, v34 row_newbcast:0 row_mask:0xf bank_mask:0xf
  v_and_b32_dpp v51, v78, v35 row_newbcast:0 row_mask:0xf bank_mask:0xf
  s_nop 1
  v_mfma_f32_16x16x32_bf16 v[44:47], v[48:51], v[224:227], v[44:47]
  s_cmp_gt_u32 s100, 7
  s_cbranch_scc1 L_lad_80
  s_waitcnt vmcnt(4)
L_lad_80:
  s_waitcnt vmcnt(5)
  buffer_load_dwordx4 v[156:159], v3, s[44:47], s14 offen offset:3072 nt
  v_and_b32_dpp v52, v78, v32 row_newbcast:4 row_mask:0xf bank_mask:0xf
  v_and_b32_dpp v53, v78, v33 row_newbcast:4 row_mask:0xf bank_mask:0xf
  v_and_b32_dpp v54, v78, v34 row_newbcast:4 row_mask:0xf bank_mask:0xf
  v_and_b32_dpp v55, v78, v35 row_newbcast:4 row_mask:0xf bank_mask:0xf
  s_nop 1
  v_mfma_f32_16x16x32_bf16 v[44:47], v[52:55], v[228:231], v[44:47]
  s_cmp_gt_u32 s100, 8
  s_cbranch_scc1 L_lad_81
  s_cmp_gt_u32 s100, 0
  s_cbranch_scc1 L_lad_82
  s_waitcnt vmcnt(4)
L_lad_82:
  s_waitcnt vmcnt(5)
L_lad_81:
  s_mov_b32 s14, 1048576
  buffer_load_dwordx4 v[208:211], v3, s[44:47], s14 offen offset:0 nt
  s_cmp_gt_u32 s100, 8
  s_cbranch_scc1 L_lad_83
  s_cmp_gt_u32 s100, 0
  s_cbranch_scc1 L_lad_84
  s_waitcnt vmcnt(4)
L_lad_84:
  s_waitcnt vmcnt(5)
L_lad_83:
  s_waitcnt vmcnt(6)
  buffer_load_dwordx4 v[212:215], v3, s[44:47], s14 offen offset:1024 nt
  ds_read_b32 v62, v63 offset:24
  v_and_b32_dpp v48, v78, v32 row_newbcast:8 row_mask:0xf bank_mask:0xf
  v_and_b32_dpp v49, v78, v33 row_newbcast:8 row_mask:0xf bank_mask:0xf
  v_and_b32_dpp v50, v78, v34 row_newbcast:8 row_mask:0xf bank_mask:0xf
  v_and_b32_dpp v51, v78, v35 row_newbcast:8 row_mask:0xf bank_mask:0xf
  s_nop 1
  v_mfma_f32_16x16x32_bf16 v[44:47], v[48:51], v[232:235], v[44:47]
  s_cmp_gt_u32 s100, 8
  s_cbranch_scc1 L_lad_85
  s_cmp_gt_u32 s100, 0
  s_cbranch_scc1 L_lad_86
  s_waitcnt vmcnt(4)
L_lad_86:
  s_waitcnt vmcnt(5)
L_lad_85:
  s_waitcnt vmcnt(6)
  buffer_load_dwordx4 v[216:219], v3, s[44:47], s14 offen offset:2048 nt
  v_and_b32_dpp v52, v78, v32 row_newbcast:12 row_mask:0xf bank_mask:0xf
  v_and_b32_dpp v53, v78, v33 row_newbcast:12 row_mask:0xf bank_mask:0xf
  v_and_b32_dpp v54, v78, v34 row_newbcast:12 row_mask:0xf bank_mask:0xf
  v_and_b32_dpp v55, v78, v35 row_newbcast:12 row_mask:0xf bank_mask:0xf
  s_nop 1
  v_mfma_f32_16x16x32_bf16 v[44:47], v[52:55], v[236:239], v[44:47]
  s_cmp_gt_u32 s100, 8
  s_cbranch_scc1 L_lad_87
  s_cmp_gt_u32 s100, 0
  s_cbranch_scc1 L_lad_88
  s_waitcnt vmcnt(4)
L_lad_88:
  s_waitcnt vmcnt(5)
L_lad_87:
  s_waitcnt vmcnt(6)
  buffer_load_dwordx4 v[220:223], v3, s[44:47], s14 offen offset:3072 nt
  s_waitcnt lgkmcnt(0)
  v_readfirstlane_b32 s100, v62
  v_and_b32_dpp v48, v79, v32 row_newbcast:0 row_mask:0xf bank_mask:0xf
  v_and_b32_dpp v49, v79, v33 row_newbcast:0 row_mask:0xf bank_mask:0xf
  v_and_b32_dpp v50, v79, v34 row_newbcast:0 row_mask:0xf bank_mask:0xf
  v_and_b32_dpp v51, v79, v35 row_newbcast:0 row_mask:0xf bank_mask:0xf
  s_nop 1
  v_mfma_f32_16x16x32_bf16 v[44:47], v[48:51], v[144:147], v[44:47]
  s_cmp_gt_u32 s100, 9
  s_cbranch_scc1 L_lad_89
  s_cmp_gt_u32 s100, 1
  s_cbranch_scc1 L_lad_90
  s_waitcnt vmcnt(4)
L_lad_90:
  s_waitcnt vmcnt(5)
L_lad_89:
  s_waitcnt vmcnt(6)
  s_mov_b32 s14, 1064960
  buffer_load_dwordx4 v[112:115], v3, s[44:47], s14 offen offset:0 nt
  v_and_b32_dpp v52, v79, v32 row_newbcast:4 row_mask:0xf bank_mask:0xf
  v_and_b32_dpp v53, v79, v33 row_newbcast:4 row_mask:0xf bank_mask:0xf
  v_and_b32_dpp v54, v79, v34 row_newbcast:4 row_mask:0xf bank_mask:0xf
  v_and_b32_dpp v55, v79, v35 row_newbcast:4 row_mask:0xf bank_mask:0xf
  s_nop 1
  v_mfma_f32_16x16x32_bf16 v[44:47], v[52:55], v[148:151], v[44:47]
  s_cmp_gt_u32 s100, 9
  s_cbranch_scc1 L_lad_91
  s_cmp_gt_u32 s100, 1
  s_cbranch_scc1 L_lad_92
  s_waitcnt vmcnt(4)
L_lad_92:
  s_waitcnt vmcnt(5)
L_lad_91:
  s_waitcnt vmcnt(6)
  buffer_load_dwordx4 v[116:119], v3, s[44:47], s14 offen offset:1024 nt
  v_and_b32_dpp v48, v79, v32 row_newbcast:8 row_mask:0xf bank_mask:0xf
  v_and_b32_dpp v49, v79, v33 row_newbcast:8 row_mask:0xf bank_mask:0xf
  v_and_b32_dpp v50, v79, v34 row_newbcast:8 row_mask:0xf bank_mask:0xf
  v_and_b32_dpp v51, v79, v35 row_newbcast:8 row_mask:0xf bank_mask:0xf
  s_nop 1
  v_mfma_f32_16x16x32_bf16 v[44:47], v[48:51], v[152:155], v[44:47]
  s_cmp_gt_u32 s100, 9
  s_cbranch_scc1 L_lad_93
  s_cmp_gt_u32 s100, 1
  s_cbranch_scc1 L_lad_94
  s_waitcnt vmcnt(4)
L_lad_94:
  s_waitcnt vmcnt(5)
L_lad_93:
  s_waitcnt vmcnt(6)
  buffer_load_dwordx4 v[120:123], v3, s[44:47], s14 offen offset:2048 nt
  ds_read_b32 v62, v63 offset:24
  v_and_b32_dpp v52, v79, v32 row_newbcast:12 row_mask:0xf bank_mask:0xf
  v_and_b32_dpp v53, v79, v33 row_newbcast:12 row_mask:0xf bank_mask:0xf
  v_and_b32_dpp v54, v79, v34 row_newbcast:12 row_mask:0xf bank_mask:0xf
  v_and_b32_dpp v55, v79, v35 row_newbcast:12 row_mask:0xf bank_mask:0xf
  s_nop 1
  v_mfma_f32_16x16x32_bf16 v[44:47], v[52:55], v[156:159], v[44:47]
  s_cmp_gt_u32 s100, 9
  s_cbranch_scc1 L_lad_95
  s_cmp_gt_u32 s100, 1
  s_cbranch_scc1 L_lad_96
  s_waitcnt vmcnt(4)
L_lad_96:
  s_waitcnt vmcnt(5)
L_lad_95:
  s_waitcnt vmcnt(6)
  buffer_load_dwordx4 v[124:127], v3, s[44:47], s14 offen offset:3072 nt
  v_and_b32_dpp v48, v80, v32 row_newbcast:0 row_mask:0xf bank_mask:0xf
  v_and_b32_dpp v49, v80, v33 row_newbcast:0 row_mask:0xf bank_mask:0xf
  v_and_b32_dpp v50, v80, v34 row_newbcast:0 row_mask:0xf bank_mask:0xf
  v_and_b32_dpp v51, v80, v35 row_newbcast:0 row_mask:0xf bank_mask:0xf
  s_nop 1
  v_mfma_f32_16x16x32_bf16 v[44:47], v[48:51], v[208:211], v[44:47]
  s_cmp_gt_u32 s100, 10
  s_cbranch_scc1 L_lad_97
  s_cmp_gt_u32 s100, 2
  s_cbranch_scc1 L_lad_98
  s_waitcnt vmcnt(4)
L_lad_98:
  s_waitcnt vmcnt(5)
L_lad_97:
  s_waitcnt vmcnt(6)
  s_mov_b32 s14, 1179648
  buffer_load_dwordx4 v[128:131], v3, s[44:47], s14 offen offset:0 nt
  s_waitcnt lgkmcnt(0)
  v_readfirstlane_b32 s100, v62
  v_and_b32_dpp v52, v80, v32 row_newbcast:4 row_mask:0xf bank_mask:0xf
  v_and_b32_dpp v53, v80, v33 row_newbcast:4 row_mask:0xf bank_mask:0xf
  v_and_b32_dpp v54, v80, v34 row_newbcast:4 row_mask:0xf bank_mask:0xf
  v_and_b32_dpp v55, v80, v35 row_newbcast:4 row_mask:0xf bank_mask:0xf
  s_nop 1
  v_mfma_f32_16x16x32_bf16 v[44:47], v[52:55], v[212:215], v[44:47]
  s_cmp_gt_u32 s100, 10
  s_cbranch_scc1 L_lad_99
  s_cmp_gt_u32 s100, 2
  s_cbranch_scc1 L_lad_100
  s_waitcnt vmcnt(4)
L_lad_100:
  s_waitcnt vmcnt(5)
L_lad_99:
  s_waitcnt vmcnt(6)
  buffer_load_dwordx4 v[132:135], v3, s[44:47], s14 offen offset:1024 nt
  v_and_b32_dpp v48, v80, v32 row_newbcast:8 row_mask:0xf bank_mask:0xf
  v_and_b32_dpp v49, v80, v33 row_newbcast:8 row_mask:0xf bank_mask:0xf
  v_and_b32_dpp v50, v80, v34 row_newbcast:8 row_mask:0xf bank_mask:0xf
  v_and_b32_dpp v51, v80, v35 row_newbcast:8 row_mask:0xf bank_mask:0xf
  s_nop 1
  v_mfma_f32_16x16x32_bf16 v[44:47], v[48:51], v[216:219], v[44:47]
  s_cmp_gt_u32 s100, 10
  s_cbranch_scc1 L_lad_101
  s_cmp_gt_u32 s100, 2
  s_cbranch_scc1 L_lad_102
  s_waitcnt vmcnt(4)
L_lad_102:
  s_waitcnt vmcnt(5)
L_lad_101:
  s_waitcnt vmcnt(6)
  buffer_load_dwordx4 v[136:139], v3, s[44:47], s14 offen offset:2048 nt
  v_and_b32_dpp v52, v80, v32 row_newbcast:12 row_mask:0xf bank_mask:0xf
  v_and_b32_dpp v53, v80, v33 row_newbcast:12 row_mask:0xf bank_mask:0xf
  v_and_b32_dpp v54, v80, v34 row_newbcast:12 row_mask:0xf bank_mask:0xf
  v_and_b32_dpp v55, v80, v35 row_newbcast:12 row_mask:0xf bank_mask:0xf
  s_nop 1
  v_mfma_f32_16x16x32_bf16 v[44:47], v[52:55], v[220:223], v[44:47]
  s_cmp_gt_u32 s100, 10
  s_cbranch_scc1 L_lad_103
  s_cmp_gt_u32 s100, 2
  s_cbranch_scc1 L_lad_104
  s_waitcnt vmcnt(4)
L_lad_104:
  s_waitcnt vmcnt(5)
L_lad_103:
  s_waitcnt vmcnt(6)
  buffer_load_dwordx4 v[140:143], v3, s[44:47], s14 offen offset:3072 nt
  ds_read_b32 v62, v63 offset:24
  v_and_b32_dpp v48, v81, v32 row_newbcast:0 row_mask:0xf bank_mask:0xf
  v_and_b32_dpp v49, v81, v33 row_newbcast:0 row_mask:0xf bank_mask:0xf
  v_and_b32_dpp v50, v81, v34 row_newbcast:0 row_mask:0xf bank_mask:0xf
  v_and_b32_dpp v51, v81, v35 row_newbcast:0 row_mask:0xf bank_mask:0xf
  s_nop 1
  v_mfma_f32_16x16x32_bf16 v[44:47], v[48:51], v[112:115], v[44:47]
  s_cmp_gt_u32 s100, 11
  s_cbranch_scc1 L_lad_105
  s_cmp_gt_u32 s100, 3
  s_cbranch_scc1 L_lad_106
  s_waitcnt vmcnt(4)
L_lad_106:
  s_waitcnt vmcnt(5)
L_lad_105:
  s_waitcnt vmcnt(6)
  s_mov_b32 s14, 1196032
  buffer_load_dwordx4 v[240:243], v3, s[44:47], s14 offen offset:0 nt
  v_and_b32_dpp v52, v81, v32 row_newbcast:4 row_mask:0xf bank_mask:0xf
  v_and_b32_dpp v53, v81, v33 row_newbcast:4 row_mask:0xf bank_mask:0xf
  v_and_b32_dpp v54, v81, v34 row_newbcast:4 row_mask:0xf bank_mask:0xf
  v_and_b32_dpp v55, v81, v35 row_newbcast:4 row_mask:0xf bank_mask:0xf
  s_nop 1
  v_mfma_f32_16x16x32_bf16 v[44:47], v[52:55], v[116:119], v[44:47]
  s_cmp_gt_u32 s100, 11
  s_cbranch_scc1 L_lad_107
  s_cmp_gt_u32 s100, 3
  s_cbranch_scc1 L_lad_108
  s_waitcnt vmcnt(4)
L_lad_108:
  s_waitcnt vmcnt(5)
L_lad_107:
  s_waitcnt vmcnt(6)
  buffer_load_dwordx4 v[244:247], v3, s[44:47], s14 offen offset:1024 nt
  s_waitcnt lgkmcnt(0)
  v_readfirstlane_b32 s100, v62
  v_and_b32_dpp v48, v81, v32 row_newbcast:8 row_mask:0xf bank_mask:0xf
  v_and_b32_dpp v49, v81, v33 row_newbcast:8 row_mask:0xf bank_mask:0xf
  v_and_b32_dpp v50, v81, v34 row_newbcast:8 row_mask:0xf bank_mask:0xf
  v_and_b32_dpp v51, v81, v35 row_newbcast:8 row_mask:0xf bank_mask:0xf
  s_nop 1
  v_mfma_f32_16x16x32_bf16 v[44:47], v[48:51], v[120:123], v[44:47]
  s_cmp_gt_u32 s100, 11
  s_cbranch_scc1 L_lad_109
  s_cmp_gt_u32 s100, 3
  s_cbranch_scc1 L_lad_110
  s_waitcnt vmcnt(4)
L_lad_110:
  s_waitcnt vmcnt(5)
L_lad_109:
  s_waitcnt vmcnt(6)
  buffer_load_dwordx4 v[248:251], v3, s[44:47], s14 offen offset:2048 nt
  v_and_b32_dpp v52, v81, v32 row_newbcast:12 row_mask:0xf bank_mask:0xf
  v_and_b32_dpp v53, v81, v33 row_newbcast:12 row_mask:0xf bank_mask:0xf
  v_and_b32_dpp v54, v81, v34 row_newbcast:12 row_mask:0xf bank_mask:0xf
  v_and_b32_dpp v55, v81, v35 row_newbcast:12 row_mask:0xf bank_mask:0xf
  s_nop 1
  v_mfma_f32_16x16x32_bf16 v[44:47], v[52:55], v[124:127], v[44:47]
  s_cmp_gt_u32 s100, 11
  s_cbranch_scc1 L_lad_111
  s_cmp_gt_u32 s100, 3
  s_cbranch_scc1 L_lad_112
  s_waitcnt vmcnt(4)
L_lad_112:
  s_waitcnt vmcnt(5)
L_lad_111:
  s_waitcnt vmcnt(6)
  buffer_load_dwordx4 v[252:255], v3, s[44:47], s14 offen offset:3072 nt
  v_and_b32_dpp v48, v82, v32 row_newbcast:0 row_mask:0xf bank_mask:0xf
  v_and_b32_dpp v49, v82, v33 row_newbcast:0 row_mask:0xf bank_mask:0xf
  v_and_b32_dpp v50, v82, v34 row_newbcast:0 row_mask:0xf bank_mask:0xf
  v_and_b32_dpp v51, v82, v35 row_newbcast:0 row_mask:0xf bank_mask:0xf
  s_nop 1
  v_mfma_f32_16x16x32_bf16 v[44:47], v[48:51], v[128:131], v[44:47]
  s_cmp_gt_u32 s100, 12
  s_cbranch_scc1 L_lad_113
  s_cmp_gt_u32 s100, 4
  s_cbranch_scc1 L_lad_114
  s_waitcnt vmcnt(4)
L_lad_114:
  s_waitcnt vmcnt(5)
L_lad_113:
  s_waitcnt vmcnt(6)
  s_mov_b32 s14, 1310720
  buffer_load_dwordx4 v[160:163], v3, s[44:47], s14 offen offset:0 nt
  ds_read_b32 v62, v63 offset:24
  v_and_b32_dpp v52, v82, v32 row_newbcast:4 row_mask:0xf bank_mask:0xf
  v_and_b32_dpp v53, v82, v33 row_newbcast:4 row_mask:0xf bank_mask:0xf
  v_and_b32_dpp v54, v82, v34 row_newbcast:4 row_mask:0xf bank_mask:0xf
  v_and_b32_dpp v55, v82, v35 row_newbcast:4 row_mask:0xf bank_mask:0xf
  s_nop 1
  v_mfma_f32_16x16x32_bf16 v[44:47], v[52:55], v[132:135], v[44:47]
  s_cmp_gt_u32 s100, 12
  s_cbranch_scc1 L_lad_115
  s_cmp_gt_u32 s100, 4
  s_cbranch_scc1 L_lad_116
  s_waitcnt vmcnt(4)
L_lad_116:
  s_waitcnt vmcnt(5)
L_lad_115:
  s_waitcnt vmcnt(6)
  buffer_load_dwordx4 v[164:167], v3, s[44:47], s14 offen offset:1024 nt
  v_and_b32_dpp v48, v82, v32 row_newbcast:8 row_mask:0xf bank_mask:0xf
  v_and_b32_dpp v49, v82, v33 row_newbcast:8 row_mask:0xf bank_mask:0xf
  v_and_b32_dpp v50, v82, v34 row_newbcast:8 row_mask:0xf bank_mask:0xf
  v_and_b32_dpp v51, v82, v35 row_newbcast:8 row_mask:0xf bank_mask:0xf
  s_nop 1
  v_mfma_f32_16x16x32_bf16 v[44:47], v[48:51], v[136:139], v[44:47]
  s_cmp_gt_u32 s100, 12
  s_cbranch_scc1 L_lad_117
  s_cmp_gt_u32 s100, 4
  s_cbranch_scc1 L_lad_118
  s_waitcnt vmcnt(4)
L_lad_118:
  s_waitcnt vmcnt(5)
L_lad_117:
  s_waitcnt vmcnt(6)
  buffer_load_dwordx4 v[168:171], v3, s[44:47], s14 offen offset:2048 nt
  s_waitcnt lgkmcnt(0)
  v_readfirstlane_b32 s100, v62
  v_and_b32_dpp v52, v82, v32 row_newbcast:12 row_mask:0xf bank_mask:0xf
  v_and_b32_dpp v53, v82, v33 row_newbcast:12 row_mask:0xf bank_mask:0xf
  v_and_b32_dpp v54, v82, v34 row_newbcast:12 row_mask:0xf bank_mask:0xf
  v_and_b32_dpp v55, v82, v35 row_newbcast:12 row_mask:0xf bank_mask:0xf
  s_nop 1
  v_mfma_f32_16x16x32_bf16 v[44:47], v[52:55], v[140:143], v[44:47]
  s_cmp_gt_u32 s100, 12
  s_cbranch_scc1 L_lad_119
  s_cmp_gt_u32 s100, 4
  s_cbranch_scc1 L_lad_120
  s_waitcnt vmcnt(4)
L_lad_120:
  s_waitcnt vmcnt(5)
L_lad_119:
  s_waitcnt vmcnt(6)
  buffer_load_dwordx4 v[172:175], v3, s[44:47], s14 offen offset:3072 nt
  v_and_b32_dpp v48, v83, v32 row_newbcast:0 row_mask:0xf bank_mask:0xf
  v_and_b32_dpp v49, v83, v33 row_newbcast:0 row_mask:0xf bank_mask:0xf
  v_and_b32_dpp v50, v83, v34 row_newbcast:0 row_mask:0xf bank_mask:0xf
  v_and_b32_dpp v51, v83, v35 row_newbcast:0 row_mask:0xf bank_mask:0xf
  s_nop 1
  v_mfma_f32_16x16x32_bf16 v[44:47], v[48:51], v[240:243], v[44:47]
  s_cmp_gt_u32 s100, 13
  s_cbranch_scc1 L_lad_121
  s_cmp_gt_u32 s100, 5
  s_cbranch_scc1 L_lad_122
  s_waitcnt vmcnt(4)
L_lad_122:
  s_waitcnt vmcnt(5)
L_lad_121:
  s_waitcnt vmcnt(6)
  s_mov_b32 s14, 1327104
  buffer_load_dwordx4 v[176:179], v3, s[44:47], s14 offen offset:0 nt
  v_and_b32_dpp v52, v83, v32 row_newbcast:4 row_mask:0xf bank_mask:0xf
  v_and_b32_dpp v53, v83, v33 row_newbcast:4 row_mask:0xf bank_mask:0xf
  v_and_b32_dpp v54, v83, v34 row_newbcast:4 row_mask:0xf bank_mask:0xf
  v_and_b32_dpp v55, v83, v35 row_newbcast:4 row_mask:0xf bank_mask:0xf
  s_nop 1
  v_mfma_f32_16x16x32_bf16 v[44:47], v[52:55], v[244:247], v[44:47]
  s_cmp_gt_u32 s100, 13
  s_cbranch_scc1 L_lad_123
  s_cmp_gt_u32 s100, 5
  s_cbranch_scc1 L_lad_124
  s_waitcnt vmcnt(4)
L_lad_124:
  s_waitcnt vmcnt(5)
L_lad_123:
  s_waitcnt vmcnt(6)
  buffer_load_dwordx4 v[180:183], v3, s[44:47], s14 offen offset:1024 nt
  v_and_b32_dpp v48, v83, v32 row_newbcast:8 row_mask:0xf bank_mask:0xf
  v_and_b32_dpp v49, v83, v33 row_newbcast:8 row_mask:0xf bank_mask:0xf
  v_and_b32_dpp v50, v83, v34 row_newbcast:8 row_mask:0xf bank_mask:0xf
  v_and_b32_dpp v51, v83, v35 row_newbcast:8 row_mask:0xf bank_mask:0xf
  s_nop 1
  v_mfma_f32_16x16x32_bf16 v[44:47], v[48:51], v[248:251], v[44:47]
  s_cmp_gt_u32 s100, 13
  s_cbranch_scc1 L_lad_125
  s_cmp_gt_u32 s100, 5
  s_cbranch_scc1 L_lad_126
  s_waitcnt vmcnt(4)
L_lad_126:
  s_waitcnt vmcnt(5)
L_lad_125:
  s_waitcnt vmcnt(6)
  buffer_load_dwordx4 v[184:187], v3, s[44:47], s14 offen offset:2048 nt
  ds_read_b32 v62, v63 offset:24
  v_and_b32_dpp v52, v83, v32 row_newbcast:12 row_mask:0xf bank_mask:0xf
  v_and_b32_dpp v53, v83, v33 row_newbcast:12 row_mask:0xf bank_mask:0xf
  v_and_b32_dpp v54, v83, v34 row_newbcast:12 row_mask:0xf bank_mask:0xf
  v_and_b32_dpp v55, v83, v35 row_newbcast:12 row_mask:0xf bank_mask:0xf
  s_nop 1
  v_mfma_f32_16x16x32_bf16 v[44:47], v[52:55], v[252:255], v[44:47]
  s_cmp_gt_u32 s100, 13
  s_cbranch_scc1 L_lad_127
  s_cmp_gt_u32 s100, 5
  s_cbranch_scc1 L_lad_128
  s_waitcnt vmcnt(4)
L_lad_128:
  s_waitcnt vmcnt(5)
L_lad_127:
  s_waitcnt vmcnt(6)
  buffer_load_dwordx4 v[188:191], v3, s[44:47], s14 offen offset:3072 nt
  v_and_b32_dpp v48, v84, v32 row_newbcast:0 row_mask:0xf bank_mask:0xf
  v_and_b32_dpp v49, v84, v33 row_newbcast:0 row_mask:0xf bank_mask:0xf
  v_and_b32_dpp v50, v84, v34 row_newbcast:0 row_mask:0xf bank_mask:0xf
  v_and_b32_dpp v51, v84, v35 row_newbcast:0 row_mask:0xf bank_mask:0xf
  s_nop 1
  v_mfma_f32_16x16x32_bf16 v[44:47], v[48:51], v[160:163], v[44:47]
  s_cmp_gt_u32 s100, 14
  s_cbranch_scc1 L_lad_129
  s_cmp_gt_u32 s100, 6
  s_cbranch_scc1 L_lad_130
  s_waitcnt vmcnt(4)
L_lad_130:
  s_waitcnt vmcnt(5)
L_lad_129:
  s_waitcnt vmcnt(6)
  s_mov_b32 s14, 1441792
  buffer_load_dwordx4 v[192:195], v3, s[44:47], s14 offen offset:0 nt
  s_waitcnt lgkmcnt(0)
  v_readfirstlane_b32 s100, v62
  v_and_b32_dpp v52, v84, v32 row_newbcast:4 row_mask:0xf bank_mask:0xf
  v_and_b32_dpp v53, v84, v33 row_newbcast:4 row_mask:0xf bank_mask:0xf
  v_and_b32_dpp v54, v84, v34 row_newbcast:4 row_mask:0xf bank_mask:0xf
  v_and_b32_dpp v55, v84, v35 row_newbcast:4 row_mask:0xf bank_mask:0xf
  s_nop 1
  v_mfma_f32_16x16x32_bf16 v[44:47], v[52:55], v[164:167], v[44:47]
  s_cmp_gt_u32 s100, 14
  s_cbranch_scc1 L_lad_131
  s_cmp_gt_u32 s100, 6
  s_cbranch_scc1 L_lad_132
  s_waitcnt vmcnt(4)
L_lad_132:
  s_waitcnt vmcnt(5)
L_lad_131:
  s_waitcnt vmcnt(6)
  buffer_load_dwordx4 v[196:199], v3, s[44:47], s14 offen offset:1024 nt
  v_and_b32_dpp v48, v84, v32 row_newbcast:8 row_mask:0xf bank_mask:0xf
  v_and_b32_dpp v49, v84, v33 row_newbcast:8 row_mask:0xf bank_mask:0xf
  v_and_b32_dpp v50, v84, v34 row_newbcast:8 row_mask:0xf bank_mask:0xf
  v_and_b32_dpp v51, v84, v35 row_newbcast:8 row_mask:0xf bank_mask:0xf
  s_nop 1
  v_mfma_f32_16x16x32_bf16 v[44:47], v[48:51], v[168:171], v[44:47]
  s_cmp_gt_u32 s100, 14
  s_cbranch_scc1 L_lad_133
  s_cmp_gt_u32 s100, 6
  s_cbranch_scc1 L_lad_134
  s_waitcnt vmcnt(4)
L_lad_134:
  s_waitcnt vmcnt(5)
L_lad_133:
  s_waitcnt vmcnt(6)
  buffer_load_dwordx4 v[200:203], v3, s[44:47], s14 offen offset:2048 nt
  v_and_b32_dpp v52, v84, v32 row_newbcast:12 row_mask:0xf bank_mask:0xf
  v_and_b32_dpp v53, v84, v33 row_newbcast:12 row_mask:0xf bank_mask:0xf
  v_and_b32_dpp v54, v84, v34 row_newbcast:12 row_mask:0xf bank_mask:0xf
  v_and_b32_dpp v55, v84, v35 row_newbcast:12 row_mask:0xf bank_mask:0xf
  s_nop 1
  v_mfma_f32_16x16x32_bf16 v[44:47], v[52:55], v[172:175], v[44:47]
  s_cmp_gt_u32 s100, 14
  s_cbranch_scc1 L_lad_135
  s_cmp_gt_u32 s100, 6
  s_cbranch_scc1 L_lad_136
  s_waitcnt vmcnt(4)
L_lad_136:
  s_waitcnt vmcnt(5)
L_lad_135:
  s_waitcnt vmcnt(6)
  buffer_load_dwordx4 v[204:207], v3, s[44:47], s14 offen offset:3072 nt
  v_and_b32_dpp v48, v85, v32 row_newbcast:0 row_mask:0xf bank_mask:0xf
  v_and_b32_dpp v49, v85, v33 row_newbcast:0 row_mask:0xf bank_mask:0xf
  v_and_b32_dpp v50, v85, v34 row_newbcast:0 row_mask:0xf bank_mask:0xf
  v_and_b32_dpp v51, v85, v35 row_newbcast:0 row_mask:0xf bank_mask:0xf
  s_nop 1
  v_mfma_f32_16x16x32_bf16 v[44:47], v[48:51], v[176:179], v[44:47]
  s_cmp_gt_u32 s100, 7
  s_cbranch_scc1 L_lad_137
  s_waitcnt vmcnt(4)
L_lad_137:
  s_waitcnt vmcnt(5)
  s_mov_b32 s14, 1458176
  buffer_load_dwordx4 v[96:99], v3, s[44:47], s14 offen offset:0 nt
  v_and_b32_dpp v52, v85, v32 row_newbcast:4 row_mask:0xf bank_mask:0xf
  v_and_b32_dpp v53, v85, v33 row_newbcast:4 row_mask:0xf bank_mask:0xf
  v_and_b32_dpp v54, v85, v34 row_newbcast:4 row_mask:0xf bank_mask:0xf
  v_and_b32_dpp v55, v85, v35 row_newbcast:4 row_mask:0xf bank_mask:0xf
  s_nop 1
  v_mfma_f32_16x16x32_bf16 v[44:47], v[52:55], v[180:183], v[44:47]
  v_and_b32_dpp v48, v85, v32 row_newbcast:8 row_mask:0xf bank_mask:0xf
  v_and_b32_dpp v49, v85, v33 row_newbcast:8 row_mask:0xf bank_mask:0xf
  v_and_b32_dpp v50, v85, v34 row_newbcast:8 row_mask:0xf bank_mask:0xf
  v_and_b32_dpp v51, v85, v35 row_newbcast:8 row_mask:0xf bank_mask:0xf
  s_nop 1
  v_mfma_f32_16x16x32_bf16 v[44:47], v[48:51], v[184:187], v[44:47]
  s_cmp_gt_u32 s100, 7
  s_cbranch_scc1 L_lad_138
  s_waitcnt vmcnt(4)
L_lad_138:
  s_waitcnt vmcnt(5)
  buffer_load_dwordx4 v[100:103], v3, s[44:47], s14 offen offset:1024 nt
  v_and_b32_dpp v52, v85, v32 row_newbcast:12 row_mask:0xf bank_mask:0xf
  v_and_b32_dpp v53, v85, v33 row_newbcast:12 row_mask:0xf bank_mask:0xf
  v_and_b32_dpp v54, v85, v34 row_newbcast:12 row_mask:0xf bank_mask:0xf
  v_and_b32_dpp v55, v85, v35 row_newbcast:12 row_mask:0xf bank_mask:0xf
  s_nop 1
  v_mfma_f32_16x16x32_bf16 v[44:47], v[52:55], v[188:191], v[44:47]
  s_cmp_gt_u32 s100, 7
  s_cbranch_scc1 L_lad_139
  s_waitcnt vmcnt(4)
L_lad_139:
  s_waitcnt vmcnt(5)
  buffer_load_dwordx4 v[104:107], v3, s[44:47], s14 offen offset:2048 nt
  ds_add_u32 v63, v0 offset:20
L_acw_140:
  v_and_b32_dpp v48, v86, v32 row_newbcast:0 row_mask:0xf bank_mask:0xf
  v_and_b32_dpp v49, v86, v33 row_newbcast:0 row_mask:0xf bank_mask:0xf
  v_and_b32_dpp v50, v86, v34 row_newbcast:0 row_mask:0xf bank_mask:0xf
  v_and_b32_dpp v51, v86, v35 row_newbcast:0 row_mask:0xf bank_mask:0xf
  s_nop 1
  v_mfma_f32_16x16x32_bf16 v[44:47], v[48:51], v[192:195], v[44:47]
  s_cmp_gt_u32 s100, 7
  s_cbranch_scc1 L_lad_141
  s_waitcnt vmcnt(4)
L_lad_141:
  s_waitcnt vmcnt(5)
  buffer_load_dwordx4 v[108:111], v3, s[44:47], s14 offen offset:3072 nt
  v_and_b32_dpp v52, v86, v32 row_newbcast:4 row_mask:0xf bank_mask:0xf
  v_and_b32_dpp v53, v86, v33 row_newbcast:4 row_mask:0xf bank_mask:0xf
  v_and_b32_dpp v54, v86, v34 row_newbcast:4 row_mask:0xf bank_mask:0xf
  v_and_b32_dpp v55, v86, v35 row_newbcast:4 row_mask:0xf bank_mask:0xf
  s_nop 1
  v_mfma_f32_16x16x32_bf16 v[44:47], v[52:55], v[196:199], v[44:47]
  s_cmp_gt_u32 s100, 8
  s_cbranch_scc1 L_lad_142
  s_cmp_gt_u32 s100, 0
  s_cbranch_scc1 L_lad_143
  s_waitcnt vmcnt(4)
L_lad_143:
  s_waitcnt vmcnt(5)
L_lad_142:
  s_mov_b32 s14, 1572864
  buffer_load_dwordx4 v[224:227], v3, s[44:47], s14 offen offset:0 nt
  s_cmp_gt_u32 s100, 8
  s_cbranch_scc1 L_lad_144
  s_cmp_gt_u32 s100, 0
  s_cbranch_scc1 L_lad_145
  s_waitcnt vmcnt(4)
L_lad_145:
  s_waitcnt vmcnt(5)
L_lad_144:
  s_waitcnt vmcnt(6)
  buffer_load_dwordx4 v[228:231], v3, s[44:47], s14 offen offset:1024 nt
  v_and_b32_dpp v48, v86, v32 row_newbcast:8 row_mask:0xf bank_mask:0xf
  v_and_b32_dpp v49, v86, v33 row_newbcast:8 row_mask:0xf bank_mask:0xf
  v_and_b32_dpp v50, v86, v34 row_newbcast:8 row_mask:0xf bank_mask:0xf
  v_and_b32_dpp v51, v86, v35 row_newbcast:8 row_mask:0xf bank_mask:0xf
  s_nop 1
  v_mfma_f32_16x16x32_bf16 v[44:47], v[48:51], v[200:203], v[44:47]
  s_cmp_gt_u32 s100, 8
  s_cbranch_scc1 L_lad_146
  s_cmp_gt_u32 s100, 0
  s_cbranch_scc1 L_lad_147
  s_waitcnt vmcnt(4)
L_lad_147:
  s_waitcnt vmcnt(5)
L_lad_146:
  s_waitcnt vmcnt(6)
  buffer_load_dwordx4 v[232:235], v3, s[44:47], s14 offen offset:2048 nt
  v_and_b32_dpp v52, v86, v32 row_newbcast:12 row_mask:0xf bank_mask:0xf
  v_and_b32_dpp v53, v86, v33 row_newbcast:12 row_mask:0xf bank_mask:0xf
  v_and_b32_dpp v54, v86, v34 row_newbcast:12 row_mask:0xf bank_mask:0xf
  v_and_b32_dpp v55, v86, v35 row_newbcast:12 row_mask:0xf bank_mask:0xf
  s_nop 1
  v_mfma_f32_16x16x32_bf16 v[44:47], v[52:55], v[204:207], v[44:47]
  s_cmp_gt_u32 s100, 8
  s_cbranch_scc1 L_lad_148
  s_cmp_gt_u32 s100, 0
  s_cbranch_scc1 L_lad_149
  s_waitcnt vmcnt(4)
L_lad_149:
  s_waitcnt vmcnt(5)
L_lad_148:
  s_waitcnt vmcnt(6)
  buffer_load_dwordx4 v[236:239], v3, s[44:47], s14 offen offset:3072 nt
  v_and_b32_dpp v48, v87, v32 row_newbcast:0 row_mask:0xf bank_mask:0xf
  v_and_b32_dpp v49, v87, v33 row_newbcast:0 row_mask:0xf bank_mask:0xf
  v_and_b32_dpp v50, v87, v34 row_newbcast:0 row_mask:0xf bank_mask:0xf
  v_and_b32_dpp v51, v87, v35 row_newbcast:0 row_mask:0xf bank_mask:0xf
  s_nop 1
  v_mfma_f32_16x16x32_bf16 v[44:47], v[48:51], v[96:99], v[44:47]
  s_cmp_gt_u32 s100, 9
  s_cbranch_scc1 L_lad_150
  s_cmp_gt_u32 s100, 1
  s_cbranch_scc1 L_lad_151
  s_waitcnt vmcnt(4)
L_lad_151:
  s_waitcnt vmcnt(5)
L_lad_150:
  s_waitcnt vmcnt(6)
  s_mov_b32 s14, 1589248
  buffer_load_dwordx4 v[144:147], v3, s[44:47], s14 offen offset:0 nt
  v_and_b32_dpp v52, v87, v32 row_newbcast:4 row_mask:0xf bank_mask:0xf
  v_and_b32_dpp v53, v87, v33 row_newbcast:4 row_mask:0xf bank_mask:0xf
  v_and_b32_dpp v54, v87, v34 row_newbcast:4 row_mask:0xf bank_mask:0xf
  v_and_b32_dpp v55, v87, v35 row_newbcast:4 row_mask:0xf bank_mask:0xf
  s_nop 1
  v_mfma_f32_16x16x32_bf16 v[44:47], v[52:55], v[100:103], v[44:47]
  s_cmp_gt_u32 s100, 9
  s_cbranch_scc1 L_lad_152
  s_cmp_gt_u32 s100, 1
  s_cbranch_scc1 L_lad_153
  s_waitcnt vmcnt(4)
L_lad_153:
  s_waitcnt vmcnt(5)
L_lad_152:
  s_waitcnt vmcnt(6)
  buffer_load_dwordx4 v[148:151], v3, s[44:47], s14 offen offset:1024 nt
  v_and_b32_dpp v48, v87, v32 row_newbcast:8 row_mask:0xf bank_mask:0xf
  v_and_b32_dpp v49, v87, v33 row_newbcast:8 row_mask:0xf bank_mask:0xf
  v_and_b32_dpp v50, v87, v34 row_newbcast:8 row_mask:0xf bank_mask:0xf
  v_and_b32_dpp v51, v87, v35 row_newbcast:8 row_mask:0xf bank_mask:0xf
  s_nop 1
  v_mfma_f32_16x16x32_bf16 v[44:47], v[48:51], v[104:107], v[44:47]
  s_cmp_gt_u32 s100, 9
  s_cbranch_scc1 L_lad_154
  s_cmp_gt_u32 s100, 1
  s_cbranch_scc1 L_lad_155
  s_waitcnt vmcnt(4)
L_lad_155:
  s_waitcnt vmcnt(5)
L_lad_154:
  s_waitcnt vmcnt(6)
  buffer_load_dwordx4 v[152:155], v3, s[44:47], s14 offen offset:2048 nt
  ds_read_b32 v62, v63 offset:24
  v_and_b32_dpp v52, v87, v32 row_newbcast:12 row_mask:0xf bank_mask:0xf
  v_and_b32_dpp v53, v87, v33 row_newbcast:12 row_mask:0xf bank_mask:0xf
  v_and_b32_dpp v54, v87, v34 row_newbcast:12 row_mask:0xf bank_mask:0xf
  v_and_b32_dpp v55, v87, v35 row_newbcast:12 row_mask:0xf bank_mask:0xf
  s_nop 1
  v_mfma_f32_16x16x32_bf16 v[44:47], v[52:55], v[108:111], v[44:47]
  s_cmp_gt_u32 s100, 9
  s_cbranch_scc1 L_lad_156
  s_cmp_gt_u32 s100, 1
  s_cbranch_scc1 L_lad_157
  s_waitcnt vmcnt(4)
L_lad_157:
  s_waitcnt vmcnt(5)
L_lad_156:
  s_waitcnt vmcnt(6)
  buffer_load_dwordx4 v[156:159], v3, s[44:47], s14 offen offset:3072 nt
  v_and_b32_dpp v48, v88, v32 row_newbcast:0 row_mask:0xf bank_mask:0xf
  v_and_b32_dpp v49, v88, v33 row_newbcast:0 row_mask:0xf bank_mask:0xf
  v_and_b32_dpp v50, v88, v34 row_newbcast:0 row_mask:0xf bank_mask:0xf
  v_and_b32_dpp v51, v88, v35 row_newbcast:0 row_mask:0xf bank_mask:0xf
  s_nop 1
  v_mfma_f32_16x16x32_bf16 v[44:47], v[48:51], v[224:227], v[44:47]
  s_cmp_gt_u32 s100, 10
  s_cbranch_scc1 L_lad_158
  s_cmp_gt_u32 s100, 2
  s_cbranch_scc1 L_lad_159
  s_waitcnt vmcnt(5)
L_lad_159:
  s_waitcnt vmcnt(6)
L_lad_158:
  s_mov_b32 s14, 1703936
  buffer_load_dwordx4 v[208:211], v3, s[44:47], s14 offen offset:0 nt
  s_waitcnt lgkmcnt(0)
  v_readfirstlane_b32 s100, v62
  v_lshlrev_b32 v58, 6, v11
  buffer_load_dwordx2 v[56:57], v58, s[56:59], s75 offen sc1
  s_cmp_gt_u32 s100, 10
  s_cbranch_scc1 L_lad_160
  s_cmp_gt_u32 s100, 2
  s_cbranch_scc1 L_lad_161
  s_waitcnt vmcnt(5)
L_lad_161:
  s_waitcnt vmcnt(6)
L_lad_160:
  s_waitcnt vmcnt(7)
  buffer_load_dwordx4 v[212:215], v3, s[44:47], s14 offen offset:1024 nt
  v_and_b32_dpp v52, v88, v32 row_newbcast:4 row_mask:0xf bank_mask:0xf
  v_and_b32_dpp v53, v88, v33 row_newbcast:4 row_mask:0xf bank_mask:0xf
  v_and_b32_dpp v54, v88, v34 row_newbcast:4 row_mask:0xf bank_mask:0xf
  v_and_b32_dpp v55, v88, v35 row_newbcast:4 row_mask:0xf bank_mask:0xf
  s_nop 1
  v_mfma_f32_16x16x32_bf16 v[44:47], v[52:55], v[228:231], v[44:47]
  v_and_b32_dpp v48, v88, v32 row_newbcast:8 row_mask:0xf bank_mask:0xf
  v_and_b32_dpp v49, v88, v33 row_newbcast:8 row_mask:0xf bank_mask:0xf
  v_and_b32_dpp v50, v88, v34 row_newbcast:8 row_mask:0xf bank_mask:0xf
  v_and_b32_dpp v51, v88, v35 row_newbcast:8 row_mask:0xf bank_mask:0xf
  s_nop 1
  v_mfma_f32_16x16x32_bf16 v[44:47], v[48:51], v[232:235], v[44:47]
  s_cmp_gt_u32 s100, 10
  s_cbranch_scc1 L_lad_162
  s_cmp_gt_u32 s100, 2
  s_cbranch_scc1 L_lad_163
  s_waitcnt vmcnt(5)
L_lad_163:
  s_waitcnt vmcnt(6)
L_lad_162:
  s_waitcnt vmcnt(7)
  buffer_load_dwordx4 v[216:219], v3, s[44:47], s14 offen offset:2048 nt
  v_and_b32_dpp v52, v88, v32 row_newbcast:12 row_mask:0xf bank_mask:0xf
  v_and_b32_dpp v53, v88, v33 row_newbcast:12 row_mask:0xf bank_mask:0xf
  v_and_b32_dpp v54, v88, v34 row_newbcast:12 row_mask:0xf bank_mask:0xf
  v_and_b32_dpp v55, v88, v35 row_newbcast:12 row_mask:0xf bank_mask:0xf
  s_nop 1
  v_mfma_f32_16x16x32_bf16 v[44:47], v[52:55], v[236:239], v[44:47]
  s_cmp_gt_u32 s100, 10
  s_cbranch_scc1 L_lad_164
  s_cmp_gt_u32 s100, 2
  s_cbranch_scc1 L_lad_165
  s_waitcnt vmcnt(5)
L_lad_165:
  s_waitcnt vmcnt(6)
L_lad_164:
  s_waitcnt vmcnt(7)
  buffer_load_dwordx4 v[220:223], v3, s[44:47], s14 offen offset:3072 nt
  ds_read_b32 v62, v63 offset:24
  v_and_b32_dpp v48, v89, v32 row_newbcast:0 row_mask:0xf bank_mask:0xf
  v_and_b32_dpp v49, v89, v33 row_newbcast:0 row_mask:0xf bank_mask:0xf
  v_and_b32_dpp v50, v89, v34 row_newbcast:0 row_mask:0xf bank_mask:0xf
  v_and_b32_dpp v51, v89, v35 row_newbcast:0 row_mask:0xf bank_mask:0xf
  s_nop 1
  v_mfma_f32_16x16x32_bf16 v[44:47], v[48:51], v[144:147], v[44:47]
  s_cmp_gt_u32 s100, 11
  s_cbranch_scc1 L_lad_166
  s_cmp_gt_u32 s100, 3
  s_cbranch_scc1 L_lad_167
  s_waitcnt vmcnt(5)
L_lad_167:
  s_waitcnt vmcnt(6)
L_lad_166:
  s_waitcnt vmcnt(7)
  s_mov_b32 s14, 1720320
  buffer_load_dwordx4 v[112:115], v3, s[44:47], s14 offen offset:0 nt
  s_lshl_b32 s10, s3, 28
  v_lshl_or_b32 v60, v1, 22, s10
  v_mov_b32 v61, 1
  s_lshl_b32 s10, s9, 8
  s_add_u32 s10, s10, 131072
  buffer_atomic_add v61, v60, s[56:59], s10 offen sc0 sc1
  v_and_b32_dpp v52, v89, v32 row_newbcast:4 row_mask:0xf bank_mask:0xf
  v_and_b32_dpp v53, v89, v33 row_newbcast:4 row_mask:0xf bank_mask:0xf
  v_and_b32_dpp v54, v89, v34 row_newbcast:4 row_mask:0xf bank_mask:0xf
  v_and_b32_dpp v55, v89, v35 row_newbcast:4 row_mask:0xf bank_mask:0xf
  s_nop 1
  v_mfma_f32_16x16x32_bf16 v[44:47], v[52:55], v[148:151], v[44:47]
  s_cmp_gt_u32 s100, 11
  s_cbranch_scc1 L_lad_168
  s_cmp_gt_u32 s100, 3
  s_cbranch_scc1 L_lad_169
  s_waitcnt vmcnt(5)
L_lad_169:
  s_waitcnt vmcnt(6)
L_lad_168:
  s_waitcnt vmcnt(7)
  buffer_load_dwordx4 v[116:119], v3, s[44:47], s14 offen offset:1024 nt
  s_waitcnt lgkmcnt(0)
  v_readfirstlane_b32 s100, v62
  v_and_b32_dpp v48, v89, v32 row_newbcast:8 row_mask:0xf bank_mask:0xf
  v_and_b32_dpp v49, v89, v33 row_newbcast:8 row_mask:0xf bank_mask:0xf
  v_and_b32_dpp v50, v89, v34 row_newbcast:8 row_mask:0xf bank_mask:0xf
  v_and_b32_dpp v51, v89, v35 row_newbcast:8 row_mask:0xf bank_mask:0xf
  s_nop 1
  v_mfma_f32_16x16x32_bf16 v[44:47], v[48:51], v[152:155], v[44:47]
  v_and_b32_dpp v52, v89, v32 row_newbcast:12 row_mask:0xf bank_mask:0xf
  v_and_b32_dpp v53, v89, v33 row_newbcast:12 row_mask:0xf bank_mask:0xf
  v_and_b32_dpp v54, v89, v34 row_newbcast:12 row_mask:0xf bank_mask:0xf
  v_and_b32_dpp v55, v89, v35 row_newbcast:12 row_mask:0xf bank_mask:0xf
  s_nop 1
  v_mfma_f32_16x16x32_bf16 v[44:47], v[52:55], v[156:159], v[44:47]
  s_cmp_gt_u32 s100, 11
  s_cbranch_scc1 L_lad_170
  s_cmp_gt_u32 s100, 3
  s_cbranch_scc1 L_lad_171
  s_waitcnt vmcnt(5)
L_lad_171:
  s_waitcnt vmcnt(6)
L_lad_170:
  s_waitcnt vmcnt(7)
  buffer_load_dwordx4 v[120:123], v3, s[44:47], s14 offen offset:2048 nt
  v_and_b32_dpp v48, v90, v32 row_newbcast:0 row_mask:0xf bank_mask:0xf
  v_and_b32_dpp v49, v90, v33 row_newbcast:0 row_mask:0xf bank_mask:0xf
  v_and_b32_dpp v50, v90, v34 row_newbcast:0 row_mask:0xf bank_mask:0xf
  v_and_b32_dpp v51, v90, v35 row_newbcast:0 row_mask:0xf bank_mask:0xf
  s_nop 1
  v_mfma_f32_16x16x32_bf16 v[44:47], v[48:51], v[208:211], v[44:47]
  s_cmp_gt_u32 s100, 11
  s_cbranch_scc1 L_lad_172
  s_cmp_gt_u32 s100, 3
  s_cbranch_scc1 L_lad_173
  s_waitcnt vmcnt(5)
L_lad_173:
  s_waitcnt vmcnt(6)
L_lad_172:
  s_waitcnt vmcnt(7)
  buffer_load_dwordx4 v[124:127], v3, s[44:47], s14 offen offset:3072 nt
  s_mov_b32 s11, 0
L_stspin_175:
  v_max_u32 v4, v56, v57
  v_cmp_eq_u32 vcc, -1, v4
  s_cbranch_vccz L_stok_174
  s_add_u32 s11, s11, 1
  s_cmp_ge_u32 s11, 16384
  s_cbranch_scc1 L_stok_174
  buffer_load_dwordx2 v[56:57], v58, s[56:59], s75 offen sc1
  s_waitcnt vmcnt(0)
  s_branch L_stspin_175
L_stok_174:
  v_mov_b32 v4, v56
  s_nop 1
  v_max_f32_dpp v4, v4, v4 row_ror:1 row_mask:0xf bank_mask:0xf
  s_nop 1
  v_max_f32_dpp v4, v4, v4 row_ror:2 row_mask:0xf bank_mask:0xf
  s_nop 1
  v_max_f32_dpp v4, v4, v4 row_ror:4 row_mask:0xf bank_mask:0xf
  s_nop 1
  v_max_f32_dpp v4, v4, v4 row_ror:8 row_mask:0xf bank_mask:0xf
  v_sub_f32 v5, v56, v4
  v_sub_f32 v6, v13, v4
  v_exp_f32 v5, v5
  v_exp_f32 v6, v6
  v_mul_f32 v5, v5, v57
  s_nop 1
  v_add_f32_dpp v5, v5, v5 row_ror:1 row_mask:0xf bank_mask:0xf
  s_nop 1
  v_add_f32_dpp v5, v5, v5 row_ror:2 row_mask:0xf bank_mask:0xf
  s_nop 1
  v_add_f32_dpp v5, v5, v5 row_ror:4 row_mask:0xf bank_mask:0xf
  s_nop 1
  v_add_f32_dpp v5, v5, v5 row_ror:8 row_mask:0xf bank_mask:0xf
  v_rcp_f32 v5, v5
  s_nop 0
  v_mul_f32 v9, v5, v6
  s_cmp_gt_u32 s100, 12
  s_cbranch_scc1 L_lad_176
  s_cmp_gt_u32 s100, 4
  s_cbranch_scc1 L_lad_177
  s_waitcnt vmcnt(5)
L_lad_177:
  s_waitcnt vmcnt(6)
L_lad_176:
  s_waitcnt vmcnt(7)
  s_mov_b32 s14, 1835008
  buffer_load_dwordx4 v[128:131], v3, s[44:47], s14 offen offset:0 nt
  ds_read_b32 v62, v63 offset:24
  v_and_b32_dpp v52, v90, v32 row_newbcast:4 row_mask:0xf bank_mask:0xf
  v_and_b32_dpp v53, v90, v33 row_newbcast:4 row_mask:0xf bank_mask:0xf
  v_and_b32_dpp v54, v90, v34 row_newbcast:4 row_mask:0xf bank_mask:0xf
  v_and_b32_dpp v55, v90, v35 row_newbcast:4 row_mask:0xf bank_mask:0xf
  s_nop 1
  v_mfma_f32_16x16x32_bf16 v[44:47], v[52:55], v[212:215], v[44:47]
  s_cmp_gt_u32 s100, 12
  s_cbranch_scc1 L_lad_178
  s_cmp_gt_u32 s100, 4
  s_cbranch_scc1 L_lad_179
  s_waitcnt vmcnt(5)
L_lad_179:
  s_waitcnt vmcnt(6)
L_lad_178:
  s_waitcnt vmcnt(7)
  buffer_load_dwordx4 v[132:135], v3, s[44:47], s14 offen offset:1024 nt
  v_and_b32_dpp v48, v90, v32 row_newbcast:8 row_mask:0xf bank_mask:0xf
  v_and_b32_dpp v49, v90, v33 row_newbcast:8 row_mask:0xf bank_mask:0xf
  v_and_b32_dpp v50, v90, v34 row_newbcast:8 row_mask:0xf bank_mask:0xf
  v_and_b32_dpp v51, v90, v35 row_newbcast:8 row_mask:0xf bank_mask:0xf
  s_nop 1
  v_mfma_f32_16x16x32_bf16 v[44:47], v[48:51], v[216:219], v[44:47]
  s_cmp_gt_u32 s100, 12
  s_cbranch_scc1 L_lad_180
  s_cmp_gt_u32 s100, 4
  s_cbranch_scc1 L_lad_181
  s_waitcnt vmcnt(5)
L_lad_181:
  s_waitcnt vmcnt(6)
L_lad_180:
  s_waitcnt vmcnt(7)
  buffer_load_dwordx4 v[136:139], v3, s[44:47], s14 offen offset:2048 nt
  s_waitcnt lgkmcnt(0)
  v_readfirstlane_b32 s100, v62
  v_and_b32_dpp v52, v90, v32 row_newbcast:12 row_mask:0xf bank_mask:0xf
  v_and_b32_dpp v53, v90, v33 row_newbcast:12 row_mask:0xf bank_mask:0xf
  v_and_b32_dpp v54, v90, v34 row_newbcast:12 row_mask:0xf bank_mask:0xf
  v_and_b32_dpp v55, v90, v35 row_newbcast:12 row_mask:0xf bank_mask:0xf
  s_nop 1
  v_mfma_f32_16x16x32_bf16 v[44:47], v[52:55], v[220:223], v[44:47]
  s_cmp_gt_u32 s100, 12
  s_cbranch_scc1 L_lad_182
  s_cmp_gt_u32 s100, 4
  s_cbranch_scc1 L_lad_183
  s_waitcnt vmcnt(5)
L_lad_183:
  s_waitcnt vmcnt(6)
L_lad_182:
  s_waitcnt vmcnt(7)
  buffer_load_dwordx4 v[140:143], v3, s[44:47], s14 offen offset:3072 nt
  v_and_b32_dpp v48, v91, v32 row_newbcast:0 row_mask:0xf bank_mask:0xf
  v_and_b32_dpp v49, v91, v33 row_newbcast:0 row_mask:0xf bank_mask:0xf
  v_and_b32_dpp v50, v91, v34 row_newbcast:0 row_mask:0xf bank_mask:0xf
  v_and_b32_dpp v51, v91, v35 row_newbcast:0 row_mask:0xf bank_mask:0xf
  s_nop 1
  v_mfma_f32_16x16x32_bf16 v[44:47], v[48:51], v[112:115], v[44:47]
  s_cmp_gt_u32 s100, 13
  s_cbranch_scc1 L_lad_184
  s_cmp_gt_u32 s100, 5
  s_cbranch_scc1 L_lad_185
  s_waitcnt vmcnt(5)
L_lad_185:
  s_waitcnt vmcnt(6)
L_lad_184:
  s_waitcnt vmcnt(7)
  s_mov_b32 s14, 1851392
  buffer_load_dwordx4 v[240:243], v3, s[44:47], s14 offen offset:0 nt
  s_cmp_lg_u32 s3, 0
  s_cbranch_scc1 L_notk_186
  v_add_u32 v61, 2, v61
  v_mov_b32 v60, 160768
  s_mov_b64 exec, 1
  ds_write_b32 v60, v61 offset:4
  s_mov_b64 exec, -1
L_notk_186:
  s_cmp_gt_u32 s100, 13
  s_cbranch_scc1 L_lad_187
  s_cmp_gt_u32 s100, 5
  s_cbranch_scc1 L_lad_188
  s_waitcnt vmcnt(5)
L_lad_188:
  s_waitcnt vmcnt(6)
L_lad_187:
  s_waitcnt vmcnt(7)
  buffer_load_dwordx4 v[244:247], v3, s[44:47], s14 offen offset:1024 nt
  ds_read_b32 v62, v63 offset:24
  v_and_b32_dpp v52, v91, v32 row_newbcast:4 row_mask:0xf bank_mask:0xf
  v_and_b32_dpp v53, v91, v33 row_newbcast:4 row_mask:0xf bank_mask:0xf
  v_and_b32_dpp v54, v91, v34 row_newbcast:4 row_mask:0xf bank_mask:0xf
  v_and_b32_dpp v55, v91, v35 row_newbcast:4 row_mask:0xf bank_mask:0xf
  s_nop 1
  v_mfma_f32_16x16x32_bf16 v[44:47], v[52:55], v[116:119], v[44:47]
  s_cmp_gt_u32 s100, 13
  s_cbranch_scc1 L_lad_189
  s_cmp_gt_u32 s100, 5
  s_cbranch_scc1 L_lad_190
  s_waitcnt vmcnt(5)
L_lad_190:
  s_waitcnt vmcnt(6)
L_lad_189:
  s_waitcnt vmcnt(7)
  buffer_load_dwordx4 v[248:251], v3, s[44:47], s14 offen offset:2048 nt
  v_and_b32_dpp v48, v91, v32 row_newbcast:8 row_mask:0xf bank_mask:0xf
  v_and_b32_dpp v49, v91, v33 row_newbcast:8 row_mask:0xf bank_mask:0xf
  v_and_b32_dpp v50, v91, v34 row_newbcast:8 row_mask:0xf bank_mask:0xf
  v_and_b32_dpp v51, v91, v35 row_newbcast:8 row_mask:0xf bank_mask:0xf
  s_nop 1
  v_mfma_f32_16x16x32_bf16 v[44:47], v[48:51], v[120:123], v[44:47]
  s_cmp_gt_u32 s100, 13
  s_cbranch_scc1 L_lad_191
  s_cmp_gt_u32 s100, 5
  s_cbranch_scc1 L_lad_192
  s_waitcnt vmcnt(5)
L_lad_192:
  s_waitcnt vmcnt(6)
L_lad_191:
  s_waitcnt vmcnt(7)
  buffer_load_dwordx4 v[252:255], v3, s[44:47], s14 offen offset:3072 nt
  s_waitcnt lgkmcnt(0)
  v_readfirstlane_b32 s100, v62
  v_and_b32_dpp v52, v91, v32 row_newbcast:12 row_mask:0xf bank_mask:0xf
  v_and_b32_dpp v53, v91, v33 row_newbcast:12 row_mask:0xf bank_mask:0xf
  v_and_b32_dpp v54, v91, v34 row_newbcast:12 row_mask:0xf bank_mask:0xf
  v_and_b32_dpp v55, v91, v35 row_newbcast:12 row_mask:0xf bank_mask:0xf
  s_nop 1
  v_mfma_f32_16x16x32_bf16 v[44:47], v[52:55], v[124:127], v[44:47]
  s_cmp_gt_u32 s100, 14
  s_cbranch_scc1 L_lad_193
  s_cmp_gt_u32 s100, 6
  s_cbranch_scc1 L_lad_194
  s_waitcnt vmcnt(5)
L_lad_194:
  s_waitcnt vmcnt(6)
L_lad_193:
  s_waitcnt vmcnt(7)
  s_mov_b32 s14, 1966080
  buffer_load_dwordx4 v[160:163], v3, s[44:47], s14 offen offset:0 nt
  v_and_b32_dpp v48, v92, v32 row_newbcast:0 row_mask:0xf bank_mask:0xf
  v_and_b32_dpp v49, v92, v33 row_newbcast:0 row_mask:0xf bank_mask:0xf
  v_and_b32_dpp v50, v92, v34 row_newbcast:0 row_mask:0xf bank_mask:0xf
  v_and_b32_dpp v51, v92, v35 row_newbcast:0 row_mask:0xf bank_mask:0xf
  s_nop 1
  v_mfma_f32_16x16x32_bf16 v[44:47], v[48:51], v[128:131], v[44:47]
  s_cmp_gt_u32 s100, 14
  s_cbranch_scc1 L_lad_195
  s_cmp_gt_u32 s100, 6
  s_cbranch_scc1 L_lad_196
  s_waitcnt vmcnt(5)
L_lad_196:
  s_waitcnt vmcnt(6)
L_lad_195:
  s_waitcnt vmcnt(7)
  buffer_load_dwordx4 v[164:167], v3, s[44:47], s14 offen offset:1024 nt
  v_and_b32_dpp v52, v92, v32 row_newbcast:4 row_mask:0xf bank_mask:0xf
  v_and_b32_dpp v53, v92, v33 row_newbcast:4 row_mask:0xf bank_mask:0xf
  v_and_b32_dpp v54, v92, v34 row_newbcast:4 row_mask:0xf bank_mask:0xf
  v_and_b32_dpp v55, v92, v35 row_newbcast:4 row_mask:0xf bank_mask:0xf
  s_nop 1
  v_mfma_f32_16x16x32_bf16 v[44:47], v[52:55], v[132:135], v[44:47]
  s_cmp_gt_u32 s100, 14
  s_cbranch_scc1 L_lad_197
  s_cmp_gt_u32 s100, 6
  s_cbranch_scc1 L_lad_198
  s_waitcnt vmcnt(5)
L_lad_198:
  s_waitcnt vmcnt(6)
L_lad_197:
  s_waitcnt vmcnt(7)
  buffer_load_dwordx4 v[168:171], v3, s[44:47], s14 offen offset:2048 nt
  v_and_b32_dpp v48, v92, v32 row_newbcast:8 row_mask:0xf bank_mask:0xf
  v_and_b32_dpp v49, v92, v33 row_newbcast:8 row_mask:0xf bank_mask:0xf
  v_and_b32_dpp v50, v92, v34 row_newbcast:8 row_mask:0xf bank_mask:0xf
  v_and_b32_dpp v51, v92, v35 row_newbcast:8 row_mask:0xf bank_mask:0xf
  s_nop 1
  v_mfma_f32_16x16x32_bf16 v[44:47], v[48:51], v[136:139], v[44:47]
  s_cmp_gt_u32 s100, 14
  s_cbranch_scc1 L_lad_199
  s_cmp_gt_u32 s100, 6
  s_cbranch_scc1 L_lad_200
  s_waitcnt vmcnt(5)
L_lad_200:
  s_waitcnt vmcnt(6)
L_lad_199:
  s_waitcnt vmcnt(7)
  buffer_load_dwordx4 v[172:175], v3, s[44:47], s14 offen offset:3072 nt
  ds_read_b32 v62, v63 offset:24
  v_and_b32_dpp v52, v92, v32 row_newbcast:12 row_mask:0xf bank_mask:0xf
  v_and_b32_dpp v53, v92, v33 row_newbcast:12 row_mask:0xf bank_mask:0xf
  v_and_b32_dpp v54, v92, v34 row_newbcast:12 row_mask:0xf bank_mask:0xf
  v_and_b32_dpp v55, v92, v35 row_newbcast:12 row_mask:0xf bank_mask:0xf
  s_nop 1
  v_mfma_f32_16x16x32_bf16 v[44:47], v[52:55], v[140:143], v[44:47]
  s_cmp_gt_u32 s100, 7
  s_cbranch_scc1 L_lad_201
  s_waitcnt vmcnt(5)
L_lad_201:
  s_waitcnt vmcnt(6)
  s_mov_b32 s14, 1982464
  buffer_load_dwordx4 v[176:179], v3, s[44:47], s14 offen offset:0 nt
  v_and_b32_dpp v48, v93, v32 row_newbcast:0 row_mask:0xf bank_mask:0xf
  v_and_b32_dpp v49, v93, v33 row_newbcast:0 row_mask:0xf bank_mask:0xf
  v_and_b32_dpp v50, v93, v34 row_newbcast:0 row_mask:0xf bank_mask:0xf
  v_and_b32_dpp v51, v93, v35 row_newbcast:0 row_mask:0xf bank_mask:0xf
  s_nop 1
  v_mfma_f32_16x16x32_bf16 v[44:47], v[48:51], v[240:243], v[44:47]
  v_and_b32_dpp v52, v93, v32 row_newbcast:4 row_mask:0xf bank_mask:0xf
  v_and_b32_dpp v53, v93, v33 row_newbcast:4 row_mask:0xf bank_mask:0xf
  v_and_b32_dpp v54, v93, v34 row_newbcast:4 row_mask:0xf bank_mask:0xf
  v_and_b32_dpp v55, v93, v35 row_newbcast:4 row_mask:0xf bank_mask:0xf
  s_nop 1
  v_mfma_f32_16x16x32_bf16 v[44:47], v[52:55], v[244:247], v[44:47]
  s_cmp_gt_u32 s100, 7
  s_cbranch_scc1 L_lad_202
  s_waitcnt vmcnt(5)
L_lad_202:
  s_waitcnt vmcnt(6)
  buffer_load_dwordx4 v[180:183], v3, s[44:47], s14 offen offset:1024 nt
  s_waitcnt lgkmcnt(0)
  v_readfirstlane_b32 s100, v62
  v_and_b32_dpp v48, v93, v32 row_newbcast:8 row_mask:0xf bank_mask:0xf
  v_and_b32_dpp v49, v93, v33 row_newbcast:8 row_mask:0xf bank_mask:0xf
  v_and_b32_dpp v50, v93, v34 row_newbcast:8 row_mask:0xf bank_mask:0xf
  v_and_b32_dpp v51, v93, v35 row_newbcast:8 row_mask:0xf bank_mask:0xf
  s_nop 1
  v_mfma_f32_16x16x32_bf16 v[44:47], v[48:51], v[248:251], v[44:47]
  s_cmp_gt_u32 s100, 7
  s_cbranch_scc1 L_lad_203
  s_waitcnt vmcnt(5)
L_lad_203:
  s_waitcnt vmcnt(6)
  buffer_load_dwordx4 v[184:187], v3, s[44:47], s14 offen offset:2048 nt
  v_and_b32_dpp v52, v93, v32 row_newbcast:12 row_mask:0xf bank_mask:0xf
  v_and_b32_dpp v53, v93, v33 row_newbcast:12 row_mask:0xf bank_mask:0xf
  v_and_b32_dpp v54, v93, v34 row_newbcast:12 row_mask:0xf bank_mask:0xf
  v_and_b32_dpp v55, v93, v35 row_newbcast:12 row_mask:0xf bank_mask:0xf
  s_nop 1
  v_mfma_f32_16x16x32_bf16 v[44:47], v[52:55], v[252:255], v[44:47]
  s_cmp_gt_u32 s100, 7
  s_cbranch_scc1 L_lad_204
  s_waitcnt vmcnt(5)
L_lad_204:
  s_waitcnt vmcnt(6)
  buffer_load_dwordx4 v[188:191], v3, s[44:47], s14 offen offset:3072 nt
  v_and_b32_dpp v48, v94, v32 row_newbcast:0 row_mask:0xf bank_mask:0xf
  v_and_b32_dpp v49, v94, v33 row_newbcast:0 row_mask:0xf bank_mask:0xf
  v_and_b32_dpp v50, v94, v34 row_newbcast:0 row_mask:0xf bank_mask:0xf
  v_and_b32_dpp v51, v94, v35 row_newbcast:0 row_mask:0xf bank_mask:0xf
  s_nop 1
  v_mfma_f32_16x16x32_bf16 v[44:47], v[48:51], v[160:163], v[44:47]
  v_lshrrev_b32 v4, 2, v1
  v_mul_u32_u24 v4, 9216, v4
  v_lshrrev_b32 v5, 5, v1
  v_and_b32 v6, 3, v1
  v_xor_b32 v5, v5, v6
  v_lshl_add_u32 v62, v5, 4, v4
  v_xor_b32 v5, 2, v5
  v_lshl_add_u32 v63, v5, 4, v4
  v_lshlrev_b32 v29, 4, v1
  v_lshrrev_b32 v4, 2, v1
  v_and_b32 v4, 3, v4
  v_and_b32 v5, 1, v1
  v_mul_u32_u24 v6, 36896, v5
  v_and_b32 v7, 2, v1
  v_lshl_add_u32 v6, v7, 2, v6
  v_lshl_add_u32 v6, v4, 6, v6
  s_mul_i32 s10, s3, 9216
  v_add_u32 v6, s10, v6
  v_and_b32 v7, 1, v10
  v_lshlrev_b32 v22, 4, v7
  v_lshl_add_u32 v7, v10, 9, v22
  v_add_u32 v36, v6, v7
  v_lshrrev_b32 v5, 1, v10
  v_lshlrev_b32 v7, 4, v5
  v_lshl_add_u32 v7, v10, 8, v7
  v_add_u32 v40, v6, v7
  v_xor_b32 v37, 16, v36
  v_xor_b32 v41, 16, v40
  v_xor_b32 v38, 32, v36
  v_xor_b32 v42, 32, v40
  v_xor_b32 v39, 48, v36
  v_xor_b32 v43, 48, v40
  v_lshrrev_b32 v6, 1, v11
  v_mul_u32_u24 v6, 16384, v6
  v_lshl_add_u32 v23, v10, 3, v6
  v_lshl_add_u32 v22, v5, 7, v22
  v_add_u32 v22, v22, v6
  v_lshl_add_u32 v4, v10, 3, v4
  v_mul_u32_u24 v4, 1152, v4
  v_and_b32 v5, 3, v1
  v_lshl_add_u32 v4, v5, 3, v4
  s_mul_i32 s10, s3, 288
  s_add_u32 s10, s10, 73728
  v_add_u32 v21, s10, v4
  v_lshlrev_b32 v4, 4, v10
  v_lshl_add_u32 v5, v11, 6, v4
  s_mul_i32 s10, s3, 1536
  s_add_u32 s10, s10, 154624
  v_add_u32 v24, s10, v5
  v_and_b32 v5, 1, v11
  v_lshlrev_b32 v5, 4, v5
  v_and_b32 v6, 4, v11
  v_lshl_add_u32 v5, v6, 3, v5
  v_and_b32 v6, 2, v11
  v_lshl_add_u32 v5, v6, 2, v5
  v_lshl_add_u32 v5, v10, 8, v5
  v_add_u32 v26, 154688, v5
  v_lshrrev_b32 v6, 3, v11
  v_lshl_add_u32 v5, v6, 7, v5
  v_add_u32 v25, 154624, v5
  v_mul_u32_u24 v5, 136, v6
  v_add_u32 v27, 155648, v5
  v_lshrrev_b32 v6, 1, v10
  v_lshlrev_b32 v5, 13, v6
  v_lshl_add_u32 v5, v11, 2, v5
  v_and_b32 v6, 1, v10
  v_lshl_or_b32 v28, v6, 30, v5
  v_mul_u32_u24 v4, 57, v1
  v_lshrrev_b32 v4, 9, v4
  v_mul_u32_u24 v5, 9, v4
  v_sub_u32 v5, v1, v5
  v_mul_u32_u24 v4, 9216, v4
  v_lshl_add_u32 v4, v5, 7, v4
  v_mov_b32 v5, 1073741824
  v_cmp_gt_u32 vcc, 54, v1
  s_nop 1
  v_cndmask_b32 v20, v5, v4, vcc
  s_mov_b32 s48, s28
  s_and_b32 s49, s29, 0xffff
  s_mov_b32 s50, 5308416
  s_mov_b32 s51, 0x20000
  s_mov_b32 s52, s30
  s_and_b32 s53, s31, 0xffff
  s_mov_b32 s54, 5308416
  s_mov_b32 s55, 0x20000
  s_mov_b32 s60, s32
  s_and_b32 s61, s33, 0xffff
  s_mov_b32 s62, 5308416
  s_mov_b32 s63, 0x20000
  v_mov_b32 v60, 160768
  s_mov_b32 s11, 0
L_tkspin_205:
  ds_read_b32 v61, v60 offset:4
  s_add_u32 s11, s11, 1
  s_cmp_ge_u32 s11, 262144
  s_waitcnt lgkmcnt(0)
  v_readfirstlane_b32 s8, v61
  s_cbranch_scc1 L_tkok_206
  s_cmp_eq_u32 s8, 0
  s_cbranch_scc1 L_tkspin_205
L_tkok_206:
  s_sub_u32 s8, s8, 1
  s_mul_i32 s15, s9, 18
  s_add_u32 s15, s15, s8
  s_mul_i32 s76, s3, 1327104
  s_lshl_b32 s77, s15, 6
  s_add_u32 s76, s76, s77
  s_mul_i32 s77, s15, 36864
  s_mul_i32 s78, s3, 9216
  s_add_u32 s77, s77, s78
  s_cmp_lt_u32 s8, 18
  s_cbranch_scc1 L_mlp_drain
  s_mul_i32 s79, s8, 36864
  s_mul_i32 s10, s3, 1327104
  s_mul_i32 s14, s9, 1152
  s_add_u32 s14, s14, s10
  s_add_u32 s79, s79, 4294893568
  s_cmp_ge_u32 s8, 31
  s_cselect_b32 s79, 1073741824, s79
  s_add_u32 s79, s79, s14
  v_and_b32_dpp v52, v94, v32 row_newbcast:4 row_mask:0xf bank_mask:0xf
  v_and_b32_dpp v53, v94, v33 row_newbcast:4 row_mask:0xf bank_mask:0xf
  v_and_b32_dpp v54, v94, v34 row_newbcast:4 row_mask:0xf bank_mask:0xf
  v_and_b32_dpp v55, v94, v35 row_newbcast:4 row_mask:0xf bank_mask:0xf
  s_waitcnt vmcnt(6)
  s_nop 0
  v_mfma_f32_16x16x32_bf16 v[44:47], v[52:55], v[164:167], v[44:47]
  v_and_b32_dpp v48, v94, v32 row_newbcast:8 row_mask:0xf bank_mask:0xf
  v_and_b32_dpp v49, v94, v33 row_newbcast:8 row_mask:0xf bank_mask:0xf
  v_and_b32_dpp v50, v94, v34 row_newbcast:8 row_mask:0xf bank_mask:0xf
  v_and_b32_dpp v51, v94, v35 row_newbcast:8 row_mask:0xf bank_mask:0xf
  s_waitcnt vmcnt(5)
  s_nop 0
  v_mfma_f32_16x16x32_bf16 v[44:47], v[48:51], v[168:171], v[44:47]
  v_and_b32_dpp v52, v94, v32 row_newbcast:12 row_mask:0xf bank_mask:0xf
  v_and_b32_dpp v53, v94, v33 row_newbcast:12 row_mask:0xf bank_mask:0xf
  v_and_b32_dpp v54, v94, v34 row_newbcast:12 row_mask:0xf bank_mask:0xf
  v_and_b32_dpp v55, v94, v35 row_newbcast:12 row_mask:0xf bank_mask:0xf
  s_waitcnt vmcnt(4)
  s_nop 0
  v_mfma_f32_16x16x32_bf16 v[44:47], v[52:55], v[172:175], v[44:47]
  v_and_b32_dpp v48, v95, v32 row_newbcast:0 row_mask:0xf bank_mask:0xf
  v_and_b32_dpp v49, v95, v33 row_newbcast:0 row_mask:0xf bank_mask:0xf
  v_and_b32_dpp v50, v95, v34 row_newbcast:0 row_mask:0xf bank_mask:0xf
  v_and_b32_dpp v51, v95, v35 row_newbcast:0 row_mask:0xf bank_mask:0xf
  s_waitcnt vmcnt(3)
  s_nop 0
  v_mfma_f32_16x16x32_bf16 v[44:47], v[48:51], v[176:179], v[44:47]
  v_and_b32_dpp v52, v95, v32 row_newbcast:4 row_mask:0xf bank_mask:0xf
  v_and_b32_dpp v53, v95, v33 row_newbcast:4 row_mask:0xf bank_mask:0xf
  v_and_b32_dpp v54, v95, v34 row_newbcast:4 row_mask:0xf bank_mask:0xf
  v_and_b32_dpp v55, v95, v35 row_newbcast:4 row_mask:0xf bank_mask:0xf
  s_waitcnt vmcnt(2)
  s_nop 0
  v_mfma_f32_16x16x32_bf16 v[44:47], v[52:55], v[180:183], v[44:47]
  v_and_b32_dpp v48, v95, v32 row_newbcast:8 row_mask:0xf bank_mask:0xf
  v_and_b32_dpp v49, v95, v33 row_newbcast:8 row_mask:0xf bank_mask:0xf
  v_and_b32_dpp v50, v95, v34 row_newbcast:8 row_mask:0xf bank_mask:0xf
  v_and_b32_dpp v51, v95, v35 row_newbcast:8 row_mask:0xf bank_mask:0xf
  s_waitcnt vmcnt(1)
  s_bfm_b64 exec, 36, 0
  buffer_load_dword v16, v20, s[48:51], s79 offen
  s_mov_b64 exec, -1
  v_mfma_f32_16x16x32_bf16 v[44:47], v[48:51], v[184:187], v[44:47]
  v_and_b32_dpp v52, v95, v32 row_newbcast:12 row_mask:0xf bank_mask:0xf
  v_and_b32_dpp v53, v95, v33 row_newbcast:12 row_mask:0xf bank_mask:0xf
  v_and_b32_dpp v54, v95, v34 row_newbcast:12 row_mask:0xf bank_mask:0xf
  v_and_b32_dpp v55, v95, v35 row_newbcast:12 row_mask:0xf bank_mask:0xf
  s_waitcnt vmcnt(1)
  s_nop 0
  v_mfma_f32_16x16x32_bf16 v[44:47], v[52:55], v[188:191], v[44:47]
  s_nop 7
  v_mul_f32 v44, v44, v9
  v_mul_f32 v45, v45, v9
  v_mul_f32 v46, v46, v9
  v_mul_f32 v47, v47, v9
  v_cvt_pk_bf16_f32 v6, v44, v45
  v_cvt_pk_bf16_f32 v7, v46, v47
  s_mov_b64 exec, 0xffffffff
  ds_write_b64 v8, v[6:7]
  s_mov_b64 exec, -1
  s_waitcnt lgkmcnt(0)
  s_barrier
  s_bfm_b64 exec, 36, 0
  buffer_load_dword v17, v20, s[52:55], s79 offen
  s_mov_b64 exec, -1
  s_cmp_ge_u32 s8, 23
  s_cbranch_scc1 L_nohelp_207
  s_mul_i32 s79, s8, 55296
  s_add_u32 s79, s79, 73728
  s_add_u32 s79, s79, s14
  s_waitcnt vmcnt(1)
  buffer_load_dword v16, v20, s[48:51], s79 offen
  s_waitcnt vmcnt(1)
  buffer_load_dword v17, v20, s[52:55], s79 offen
L_nohelp_207:
  s_lshl_b32 s10, s3, 8
  s_add_u32 s10, s10, s8
  s_sub_u32 s10, s10, 23
  s_cmp_lt_u32 s10, 9
  s_cbranch_scc1 L_red
  s_waitcnt vmcnt(0)
  s_cmp_lg_u32 s3, 0
  s_cbranch_scc1 L_end
  s_endpgm
.p2align 7
L_mlp_drain:
  s_and_b32 s10, s15, 1
  s_mul_i32 s14, s10, 294912
  s_add_u32 s76, s76, s14
  s_add_u32 s101, s14, 147456
  s_lshl_b32 s14, s14, 1
  s_sub_u32 s100, 147456, s14
  s_lshl_b32 s10, s10, 11
  s_add_u32 s14, s78, s10
  s_sub_u32 s79, s78, s10
  v_and_b32_dpp v52, v94, v32 row_newbcast:4 row_mask:0xf bank_mask:0xf
  v_and_b32_dpp v53, v94, v33 row_newbcast:4 row_mask:0xf bank_mask:0xf
  v_and_b32_dpp v54, v94, v34 row_newbcast:4 row_mask:0xf bank_mask:0xf
  v_and_b32_dpp v55, v94, v35 row_newbcast:4 row_mask:0xf bank_mask:0xf
  s_waitcnt vmcnt(6)
  s_nop 0
  v_mfma_f32_16x16x32_bf16 v[44:47], v[52:55], v[164:167], v[44:47]
  v_and_b32_dpp v48, v94, v32 row_newbcast:8 row_mask:0xf bank_mask:0xf
  v_and_b32_dpp v49, v94, v33 row_newbcast:8 row_mask:0xf bank_mask:0xf
  v_and_b32_dpp v50, v94, v34 row_newbcast:8 row_mask:0xf bank_mask:0xf
  v_and_b32_dpp v51, v94, v35 row_newbcast:8 row_mask:0xf bank_mask:0xf
  s_waitcnt vmcnt(5)
  s_nop 0
  v_mfma_f32_16x16x32_bf16 v[44:47], v[48:51], v[168:171], v[44:47]
  v_and_b32_dpp v52, v94, v32 row_newbcast:12 row_mask:0xf bank_mask:0xf
  v_and_b32_dpp v53, v94, v33 row_newbcast:12 row_mask:0xf bank_mask:0xf
  v_and_b32_dpp v54, v94, v34 row_newbcast:12 row_mask:0xf bank_mask:0xf
  v_and_b32_dpp v55, v94, v35 row_newbcast:12 row_mask:0xf bank_mask:0xf
  s_waitcnt vmcnt(4)
  s_add_u32 m0, s14, 0
  s_nop 0
  buffer_load_dwordx4 v62, s[48:51], s76 offen  lds
  v_mfma_f32_16x16x32_bf16 v[44:47], v[52:55], v[172:175], v[44:47]
  v_and_b32_dpp v48, v95, v32 row_newbcast:0 row_mask:0xf bank_mask:0xf
  v_and_b32_dpp v49, v95, v33 row_newbcast:0 row_mask:0xf bank_mask:0xf
  v_and_b32_dpp v50, v95, v34 row_newbcast:0 row_mask:0xf bank_mask:0xf
  v_and_b32_dpp v51, v95, v35 row_newbcast:0 row_mask:0xf bank_mask:0xf
  s_waitcnt vmcnt(4)
  s_nop 0
  v_mfma_f32_16x16x32_bf16 v[44:47], v[48:51], v[176:179], v[44:47]
  v_and_b32_dpp v52, v95, v32 row_newbcast:4 row_mask:0xf bank_mask:0xf
  v_and_b32_dpp v53, v95, v33 row_newbcast:4 row_mask:0xf bank_mask:0xf
  v_and_b32_dpp v54, v95, v34 row_newbcast:4 row_mask:0xf bank_mask:0xf
  v_and_b32_dpp v55, v95, v35 row_newbcast:4 row_mask:0xf bank_mask:0xf
  s_waitcnt vmcnt(3)
  s_add_u32 m0, s14, 36864
  s_nop 0
  buffer_load_dwordx4 v63, s[52:55], s76 offen  lds
  s_add_u32 s76, s76, 147456
  v_mfma_f32_16x16x32_bf16 v[44:47], v[52:55], v[180:183], v[44:47]
  v_and_b32_dpp v48, v95, v32 row_newbcast:8 row_mask:0xf bank_mask:0xf
  v_and_b32_dpp v49, v95, v33 row_newbcast:8 row_mask:0xf bank_mask:0xf
  v_and_b32_dpp v50, v95, v34 row_newbcast:8 row_mask:0xf bank_mask:0xf
  v_and_b32_dpp v51, v95, v35 row_newbcast:8 row_mask:0xf bank_mask:0xf
  s_waitcnt vmcnt(3)
  s_nop 0
  v_mfma_f32_16x16x32_bf16 v[44:47], v[48:51], v[184:187], v[44:47]
  v_and_b32_dpp v52, v95, v32 row_newbcast:12 row_mask:0xf bank_mask:0xf
  v_and_b32_dpp v53, v95, v33 row_newbcast:12 row_mask:0xf bank_mask:0xf
  v_and_b32_dpp v54, v95, v34 row_newbcast:12 row_mask:0xf bank_mask:0xf
  v_and_b32_dpp v55, v95, v35 row_newbcast:12 row_mask:0xf bank_mask:0xf
  s_waitcnt vmcnt(2)
  s_add_u32 m0, s14, 1024
  s_nop 0
  buffer_load_dwordx4 v62, s[48:51], s76 offen  lds
  v_mfma_f32_16x16x32_bf16 v[44:47], v[52:55], v[188:191], v[44:47]
  s_nop 7
  v_mul_f32 v44, v44, v9
  v_mul_f32 v45, v45, v9
  v_mul_f32 v46, v46, v9
  v_mul_f32 v47, v47, v9
  v_cvt_pk_bf16_f32 v6, v44, v45
  v_cvt_pk_bf16_f32 v7, v46, v47
  s_mov_b64 exec, 0xffffffff
  ds_write_b64 v8, v[6:7]
  s_mov_b64 exec, -1
  s_waitcnt lgkmcnt(0)
  s_barrier
  s_add_u32 m0, s14, 37888
  s_nop 0
  buffer_load_dwordx4 v63, s[52:55], s76 offen  lds
  s_add_u32 s76, s76, s100
  s_add_u32 m0, s78, 73728
  s_nop 0
  buffer_load_dwordx4 v29, s[60:63], s77 offen  lds
  s_add_u32 s77, s77, 1024
  s_add_u32 m0, s78, 74752
  s_nop 0
  buffer_load_dwordx4 v29, s[60:63], s77 offen  lds
  s_add_u32 s77, s77, 1024
  s_add_u32 m0, s78, 75776
  s_nop 0
  buffer_load_dwordx4 v29, s[60:63], s77 offen  lds
  s_add_u32 s77, s77, 1024
  s_add_u32 m0, s78, 76800
  s_nop 0
  buffer_load_dwordx4 v29, s[60:63], s77 offen  lds
  s_add_u32 s77, s77, 1024
  s_add_u32 m0, s78, 77824
  s_nop 0
  buffer_load_dwordx4 v29, s[60:63], s77 offen  lds
  s_add_u32 s77, s77, 1024
  s_add_u32 m0, s78, 78848
  s_nop 0
  buffer_load_dwordx4 v29, s[60:63], s77 offen  lds
  s_add_u32 s77, s77, 1024
  s_mov_b32 s64, 0x50005
  s_mov_b32 s65, 0x50005
  s_mov_b32 s66, 0x70007
  s_mov_b32 s67, 0x70007
  s_mov_b32 s44, 0x01010101
  s_mov_b32 s45, 0x01010101
  s_mov_b32 s40, 0x3ae38e39
  s_mov_b32 s41, 0x3ae38e39
  s_mov_b32 s42, 0xbdd2d3e8
  v_mov_b32 v12, 0xc0135761
  v_mov_b32 v4, 0x3f803f80
  v_mov_b32 v204, v4
  v_mov_b32 v205, v4
  v_mov_b32 v206, v4
  v_mov_b32 v207, v4
  v_mov_b32 v208, v4
  v_mov_b32 v209, v4
  v_mov_b32 v210, v4
  v_mov_b32 v211, v4
  v_mov_b32 v212, v4
  v_mov_b32 v213, v4
  v_mov_b32 v214, v4
  v_mov_b32 v215, v4
  v_mov_b32 v216, v4
  v_mov_b32 v217, v4
  v_mov_b32 v218, v4
  v_mov_b32 v219, v4
  v_mov_b32 v220, v4
  v_mov_b32 v221, v4
  s_mov_b32 s11, 0
  s_mov_b32 s71, 0
  s_mul_i32 s68, s3, 1152
  s_lshl_b32 s10, s69, 13
  s_add_u32 s68, s68, s10
  s_lshr_b32 s10, s70, 1
  s_and_b32 s10, s10, 1
  s_lshl_b32 s10, s10, 15
  s_add_u32 s68, s68, s10
  s_add_u32 s68, s68, 65536
  s_mul_i32 s12, s3, 147456
  s_lshl_b32 s10, s15, 6
  s_add_u32 s12, s12, s10
  s_cmp_lt_u32 s15, 128
  s_mov_b32 s10, 1335296
  s_cselect_b32 s10, 753664, s10
  s_add_u32 s12, s12, s10
  s_waitcnt vmcnt(9)
  s_add_u32 m0, s78, 79872
  s_nop 0
  buffer_load_dwordx4 v29, s[60:63], s77 offen  lds
  s_add_u32 s77, s77, 1024
  s_add_u32 m0, s78, 80896
  s_nop 0
  buffer_load_dwordx4 v29, s[60:63], s77 offen  lds
  s_add_u32 s77, s77, 1024
  s_waitcnt vmcnt(10)
  s_add_u32 m0, s78, 81920
  s_nop 0
  buffer_load_dwordx4 v29, s[60:63], s77 offen  lds
  s_waitcnt vmcnt(10)
  s_add_u32 m0, s79, 2048
  s_nop 0
  buffer_load_dwordx4 v62, s[48:51], s76 offen  lds
  s_waitcnt vmcnt(10)
  s_add_u32 m0, s79, 38912
  s_nop 0
  buffer_load_dwordx4 v63, s[52:55], s76 offen  lds
  s_add_u32 s76, s76, 147456
  s_waitcnt vmcnt(10)
  s_add_u32 m0, s79, 3072
  s_nop 0
  buffer_load_dwordx4 v62, s[48:51], s76 offen  lds
  s_waitcnt vmcnt(9)
  s_add_u32 m0, s79, 39936
  s_nop 0
  buffer_load_dwordx4 v63, s[52:55], s76 offen  lds
  s_add_u32 s76, s76, s101
  s_waitcnt vmcnt(8)
  s_add_u32 m0, s78, 4096
  s_nop 0
  buffer_load_dwordx4 v62, s[48:51], s76 offen  lds
  s_waitcnt vmcnt(7)
  s_add_u32 m0, s78, 40960
  s_nop 0
  buffer_load_dwordx4 v63, s[52:55], s76 offen  lds
  s_add_u32 s76, s76, 147456
  s_waitcnt vmcnt(6)
  s_add_u32 m0, s78, 5120
  s_nop 0
  buffer_load_dwordx4 v62, s[48:51], s76 offen  lds
  s_barrier
  ds_read_b64_tr_b16 v[168:169], v21 offset:0
  ds_read_b64_tr_b16 v[170:171], v21 offset:4608
  ds_read_b64_tr_b16 v[172:173], v21 offset:32
  ds_read_b64_tr_b16 v[174:175], v21 offset:4640
  ds_read_b64_tr_b16 v[176:177], v21 offset:64
  ds_read_b64_tr_b16 v[178:179], v21 offset:4672
  ds_read_b64_tr_b16 v[180:181], v21 offset:96
  ds_read_b64_tr_b16 v[182:183], v21 offset:4704
  ds_read_b64_tr_b16 v[184:185], v21 offset:128
  ds_read_b64_tr_b16 v[186:187], v21 offset:4736
  ds_read_b64_tr_b16 v[188:189], v21 offset:160
  ds_read_b64_tr_b16 v[190:191], v21 offset:4768
  ds_read_b64_tr_b16 v[192:193], v21 offset:192
  ds_read_b64_tr_b16 v[194:195], v21 offset:4800
  ds_read_b64_tr_b16 v[196:197], v21 offset:224
  ds_read_b64_tr_b16 v[198:199], v21 offset:4832
  ds_read_b64_tr_b16 v[200:201], v21 offset:256
  ds_read_b64_tr_b16 v[202:203], v21 offset:4864
  s_waitcnt vmcnt(6)
  s_add_u32 m0, s78, 41984
  s_nop 0
  buffer_load_dwordx4 v63, s[52:55], s76 offen  lds
  s_add_u32 s76, s76, 147456
  s_waitcnt vmcnt(6)
  s_add_u32 m0, s78, 6144
  s_nop 0
  buffer_load_dwordx4 v62, s[48:51], s76 offen  lds
  s_waitcnt vmcnt(6)
  s_add_u32 m0, s78, 43008
  s_nop 0
  buffer_load_dwordx4 v63, s[52:55], s76 offen  lds
  s_add_u32 s76, s76, 147456
  s_waitcnt vmcnt(6)
  s_add_u32 m0, s78, 7168
  s_nop 0
  buffer_load_dwordx4 v62, s[48:51], s76 offen  lds
  ds_read_b64_tr_b16 v[98:99], v36 offset:0
  ds_read_b64_tr_b16 v[100:101], v36 offset:256
  ds_read_b64_tr_b16 v[116:117], v37 offset:0
  ds_read_b64_tr_b16 v[118:119], v37 offset:256
  ds_read_b64_tr_b16 v[134:135], v38 offset:0
  ds_read_b64_tr_b16 v[136:137], v38 offset:256
  ds_read_b64_tr_b16 v[152:153], v39 offset:0
  ds_read_b64_tr_b16 v[154:155], v39 offset:256
  ds_read_b64_tr_b16 v[102:103], v36 offset:2048
  ds_read_b64_tr_b16 v[104:105], v36 offset:2304
  ds_read_b64_tr_b16 v[120:121], v37 offset:2048
  ds_read_b64_tr_b16 v[122:123], v37 offset:2304
  ds_read_b64_tr_b16 v[138:139], v38 offset:2048
  ds_read_b64_tr_b16 v[140:141], v38 offset:2304
  ds_read_b64_tr_b16 v[156:157], v39 offset:2048
  ds_read_b64_tr_b16 v[158:159], v39 offset:2304
  s_waitcnt vmcnt(6)
  s_add_u32 m0, s78, 44032
  s_nop 0
  buffer_load_dwordx4 v63, s[52:55], s76 offen  lds
  s_add_u32 s76, s76, 147456
  s_waitcnt vmcnt(6)
  s_add_u32 m0, s78, 8192
  s_nop 0
  buffer_load_dwordx4 v62, s[48:51], s76 offen  lds
  s_waitcnt vmcnt(6)
  s_add_u32 m0, s78, 45056
  s_nop 0
  buffer_load_dwordx4 v63, s[52:55], s76 offen  lds
  s_waitcnt vmcnt(6)
  ds_read_b64_tr_b16 v[106:107], v36 offset:4096
  ds_read_b64_tr_b16 v[108:109], v36 offset:4352
  ds_read_b64_tr_b16 v[124:125], v37 offset:4096
  ds_read_b64_tr_b16 v[126:127], v37 offset:4352
  ds_read_b64_tr_b16 v[142:143], v38 offset:4096
  ds_read_b64_tr_b16 v[144:145], v38 offset:4352
  ds_read_b64_tr_b16 v[160:161], v39 offset:4096
  ds_read_b64_tr_b16 v[162:163], v39 offset:4352
  s_waitcnt vmcnt(2)
  s_mov_b64 exec, s[64:65]
  buffer_load_dwordx2 v[204:205], v23, s[56:59], s68 offen offset:1024 sc1
  buffer_load_dwordx4 v[206:209], v22, s[56:59], s68 offen offset:0 sc1
  buffer_load_dwordx4 v[210:213], v22, s[56:59], s68 offen offset:256 sc1
  buffer_load_dwordx4 v[214:217], v22, s[56:59], s68 offen offset:512 sc1
  buffer_load_dwordx4 v[218:221], v22, s[56:59], s68 offen offset:768 sc1
  s_mov_b64 exec, -1
  ds_read_b64_tr_b16 v[110:111], v36 offset:6144
  ds_read_b64_tr_b16 v[112:113], v36 offset:6400
  ds_read_b64_tr_b16 v[128:129], v37 offset:6144
  ds_read_b64_tr_b16 v[130:131], v37 offset:6400
  ds_read_b64_tr_b16 v[146:147], v38 offset:6144
  ds_read_b64_tr_b16 v[148:149], v38 offset:6400
  ds_read_b64_tr_b16 v[164:165], v39 offset:6144
  ds_read_b64_tr_b16 v[166:167], v39 offset:6400
  s_waitcnt vmcnt(5)
  ds_read_b64_tr_b16 v[96:97], v40 offset:8192
  ds_read_b64_tr_b16 v[114:115], v41 offset:8192
  ds_read_b64_tr_b16 v[132:133], v42 offset:8192
  ds_read_b64_tr_b16 v[150:151], v43 offset:8192
  s_waitcnt lgkmcnt(0)
L_mb0:
  s_waitcnt vmcnt(4)
  v_mfma_f32_16x16x16_bf16 v[80:83], v[204:205], v[204:205], 0
  v_mfma_f32_16x16x16_bf16 v[64:67], v[96:97], v[204:205], 0
  v_mfma_f32_16x16x16_bf16 v[68:71], v[114:115], v[204:205], 0
  v_mfma_f32_16x16x16_bf16 v[72:75], v[132:133], v[204:205], 0
  v_mfma_f32_16x16x16_bf16 v[76:79], v[150:151], v[204:205], 0
  s_waitcnt vmcnt(3)
  s_nop 0
  v_mfma_f32_16x16x32_bf16 v[80:83], v[206:209], v[206:209], v[80:83]
  s_waitcnt vmcnt(2)
  v_mfma_f32_16x16x32_bf16 v[80:83], v[210:213], v[210:213], v[80:83]
  s_waitcnt vmcnt(1)
  v_mfma_f32_16x16x32_bf16 v[80:83], v[214:217], v[214:217], v[80:83]
  s_waitcnt vmcnt(0)
  v_mfma_f32_16x16x32_bf16 v[80:83], v[218:221], v[218:221], v[80:83]
  v_mfma_f32_16x16x32_bf16 v[64:67], v[98:101], v[206:209], v[64:67]
  v_mfma_f32_16x16x32_bf16 v[64:67], v[102:105], v[210:213], v[64:67]
  v_mfma_f32_16x16x32_bf16 v[64:67], v[106:109], v[214:217], v[64:67]
  s_nop 4
  v_cmp_u_f32 vcc, v80, v82
  v_mfma_f32_16x16x32_bf16 v[64:67], v[110:113], v[218:221], v[64:67]
  s_cbranch_vccnz L_mchk
L_mlast:
  v_mfma_f32_16x16x32_bf16 v[68:71], v[116:119], v[206:209], v[68:71]
  s_mov_b64 exec, s[66:67]
  ds_write_b128 v24, v[80:83] offset:1024
  s_mov_b64 exec, -1
  v_mfma_f32_16x16x32_bf16 v[68:71], v[120:123], v[210:213], v[68:71]
  s_cmp_lg_u32 s71, 0
  v_mfma_f32_16x16x32_bf16 v[68:71], v[124:127], v[214:217], v[68:71]
  v_permlane16_swap_b32 v64, v65
  v_permlane16_swap_b32 v66, v67
  v_mfma_f32_16x16x32_bf16 v[68:71], v[128:131], v[218:221], v[68:71]
  s_mov_b64 exec, s[66:67]
  ds_write_b128 v24, v[64:67] offset:0
  s_mov_b64 exec, -1
  v_mfma_f32_16x16x32_bf16 v[72:75], v[134:137], v[206:209], v[72:75]
  v_mfma_f32_16x16x32_bf16 v[72:75], v[138:141], v[210:213], v[72:75]
  v_mfma_f32_16x16x32_bf16 v[72:75], v[142:145], v[214:217], v[72:75]
  s_nop 1
  v_permlane16_swap_b32 v68, v69
  v_permlane16_swap_b32 v70, v71
  v_mfma_f32_16x16x32_bf16 v[72:75], v[146:149], v[218:221], v[72:75]
  s_mov_b64 exec, s[66:67]
  ds_write_b128 v24, v[68:71] offset:256
  s_mov_b64 exec, -1
  v_mfma_f32_16x16x32_bf16 v[76:79], v[152:155], v[206:209], v[76:79]
  v_mfma_f32_16x16x32_bf16 v[76:79], v[156:159], v[210:213], v[76:79]
  v_mfma_f32_16x16x32_bf16 v[76:79], v[160:163], v[214:217], v[76:79]
  v_mfma_f32_16x16x32_bf16 v[76:79], v[164:167], v[218:221], v[76:79]
L_mgo:
  s_nop 0
  v_permlane16_swap_b32 v72, v73
  v_permlane16_swap_b32 v74, v75
  s_mov_b64 exec, s[66:67]
  ds_write_b128 v24, v[72:75] offset:512
  s_mov_b64 exec, -1
  s_nop 1
  v_permlane16_swap_b32 v76, v77
  v_permlane16_swap_b32 v78, v79
  s_mov_b64 exec, s[66:67]
  ds_write_b128 v24, v[76:79] offset:768
  s_mov_b64 exec, -1
  s_cbranch_scc1 L_mnobar
  s_waitcnt lgkmcnt(0)
  s_barrier
L_mnobar:
  ds_read2st64_b64 v[248:251], v27 offset0:0 offset1:3
  ds_read2st64_b64 v[252:255], v27 offset0:6 offset1:9
  ds_read2st64_b64 v[240:243], v26 offset0:0 offset1:3
  ds_read2st64_b64 v[244:247], v26 offset0:6 offset1:9
  ds_read2st64_b64 v[84:87], v25 offset0:0 offset1:3
  ds_read2st64_b64 v[88:91], v25 offset0:6 offset1:9
  s_waitcnt lgkmcnt(4)
  v_pk_add_f32 v[248:249], v[248:249], v[250:251]
  v_pk_add_f32 v[252:253], v[252:253], v[254:255]
  v_pk_add_f32 v[248:249], v[248:249], v[252:253]
  v_pk_mul_f32 v[248:249], v[248:249], s[40:41]
  v_fma_f32 v4, -v249, v249, v248
  v_max_f32 v4, 0, v4
  v_cvt_pk_bf16_f32 v4, v4, v249
  v_lshlrev_b32 v5, 16, v4
  v_add_f32 v5, 0x3727c5ac, v5
  v_cvt_pk_bf16_f32 v5, v5, v5
  v_and_b32 v5, 0xffff0000, v5
  v_sqrt_f32 v5, v5
  s_waitcnt lgkmcnt(0)
  v_pk_add_f32 v[240:241], v[240:241], v[242:243]
  v_cvt_pk_bf16_f32 v5, v5, v5
  v_and_b32 v5, 0xffff0000, v5
  v_rcp_f32 v6, v5
  v_pk_add_f32 v[244:245], v[244:245], v[246:247]
  v_pk_add_f32 v[84:85], v[84:85], v[86:87]
  v_pk_add_f32 v[88:89], v[88:89], v[90:91]
  v_pk_add_f32 v[240:241], v[240:241], v[244:245]
  v_pk_add_f32 v[84:85], v[84:85], v[88:89]
  v_and_b32 v7, 0xffff0000, v4
  v_pk_fma_f32 v[84:85], v[240:241], v[6:7], v[84:85] op_sel:[0,1,0] op_sel_hi:[1,1,1] neg_lo:[1,0,0] neg_hi:[1,0,0]
  v_pk_mul_f32 v[84:85], v[84:85], v[6:7] op_sel_hi:[1,0]
  v_cvt_pk_bf16_f32 v4, v84, v85
  v_lshlrev_b32 v8, 16, v4
  v_mul_f32 v5, v8, v8
  v_fma_f32 v5, v5, s42, v12
  v_mul_f32 v5, v5, v8
  v_exp_f32 v5, v5
  v_and_b32 v9, 0xffff0000, v4
  v_add_f32 v5, 1.0, v5
  v_rcp_f32 v5, v5
  s_nop 0
  v_mul_f32 v5, v5, v8
  v_cvt_pk_bf16_f32 v5, v5, v5
  v_and_b32 v5, 0xffff0000, v5
  v_mul_f32 v4, v5, v9
  s_nop 1
  v_mov_b32_dpp v5, v4 row_shl:1 row_mask:0xf bank_mask:0xf
  v_cvt_pk_bf16_f32 v32, v4, v5
  s_nop 1
  v_mov_b32_dpp v33, v32 row_shl:2 row_mask:0xf bank_mask:0xf
  v_mov_b32_dpp v34, v32 row_shl:4 row_mask:0xf bank_mask:0xf
  v_mov_b32_dpp v35, v32 row_shl:6 row_mask:0xf bank_mask:0xf
  s_nop 1
  v_mfma_f32_16x16x32_bf16 v[96:99], v[32:35], v[168:171], 0
  v_mfma_f32_16x16x32_bf16 v[100:103], v[32:35], v[172:175], 0
  v_mfma_f32_16x16x32_bf16 v[104:107], v[32:35], v[176:179], 0
  v_mfma_f32_16x16x32_bf16 v[108:111], v[32:35], v[180:183], 0
  s_nop 4
  buffer_store_dword v96, v28, s[56:59], s12 offen sc1
  s_add_u32 s12, s12, 16384
  v_mfma_f32_16x16x32_bf16 v[112:115], v[32:35], v[184:187], 0
  buffer_store_dword v100, v28, s[56:59], s12 offen sc1
  s_add_u32 s12, s12, 16384
  v_mfma_f32_16x16x32_bf16 v[116:119], v[32:35], v[188:191], 0
  buffer_store_dword v104, v28, s[56:59], s12 offen sc1
  s_add_u32 s12, s12, 16384
  v_mfma_f32_16x16x32_bf16 v[120:123], v[32:35], v[192:195], 0
  buffer_store_dword v108, v28, s[56:59], s12 offen sc1
  s_add_u32 s12, s12, 16384
  v_mfma_f32_16x16x32_bf16 v[124:127], v[32:35], v[196:199], 0
  buffer_store_dword v112, v28, s[56:59], s12 offen sc1
  s_add_u32 s12, s12, 16384
  v_mfma_f32_16x16x32_bf16 v[128:131], v[32:35], v[200:203], 0
  buffer_store_dword v116, v28, s[56:59], s12 offen sc1
  s_add_u32 s12, s12, 16384
  buffer_store_dword v120, v28, s[56:59], s12 offen sc1
  s_add_u32 s12, s12, 16384
  s_nop 0
  buffer_store_dword v124, v28, s[56:59], s12 offen sc1
  s_add_u32 s12, s12, 16384
  s_nop 0
  buffer_store_dword v128, v28, s[56:59], s12 offen sc1
  s_endpgm
L_mchk:
  s_cmp_ge_u32 s11, 16384
  s_cbranch_scc1 L_mlast
  s_mov_b64 exec, s[64:65]
  buffer_load_dwordx2 v[204:205], v23, s[56:59], s68 offen offset:1024 sc1
  buffer_load_dwordx4 v[206:209], v22, s[56:59], s68 offen offset:0 sc1
  buffer_load_dwordx4 v[210:213], v22, s[56:59], s68 offen offset:256 sc1
  buffer_load_dwordx4 v[214:217], v22, s[56:59], s68 offen offset:512 sc1
  buffer_load_dwordx4 v[218:221], v22, s[56:59], s68 offen offset:768 sc1
  s_mov_b64 exec, -1
  s_add_u32 s11, s11, 1
  s_branch L_mb0
L_aux_other:
  s_setprio 0
  s_waitcnt lgkmcnt(0)
  s_mov_b32 s56, s38
  s_and_b32 s57, s39, 0xffff
  s_mov_b32 s58, 4194304
  s_mov_b32 s59, 0x20000
  s_lshl_b32 s10, s3, 8
  s_add_u32 s10, s10, s8
  s_cmp_eq_u32 s10, 0x100
  s_cbranch_scc1 L_agg0_214
  s_cmp_lg_u32 s3, 2
  s_cbranch_scc1 L_nocl_216
  v_cmp_gt_u32 vcc, 32, v1
  v_mov_b32 v4, 1073741824
  s_mul_i32 s10, s2, 4608
  v_cndmask_b32 v4, v4, v20, vcc
  s_add_u32 s10, s10, 163840
  s_add_u32 s11, s10, 4096
  s_lshl_b32 s12, s2, 10
  s_add_u32 s12, s12, 4294959104
  s_cmp_lt_u32 s2, 144
  s_cselect_b32 s12, s12, 1073741824
  s_lshl_b32 s14, s2, 13
  s_add_u32 s14, s14, 1343488
  s_cmp_lt_u32 s2, 72
  s_cselect_b32 s12, s14, s12
  s_and_b32 s69, s2, 63
  s_and_b32 s14, s69, 7
  s_mul_i32 s14, s14, 288
  s_xor_b32 s14, s14, 32
  s_and_b32 s68, s69, 3
  s_lshl_b32 s68, s68, 3
  s_add_u32 s14, s14, s68
  s_lshr_b32 s68, s69, 3
  s_add_u32 s14, s14, s68
  s_lshl_b32 s14, s14, 10
  s_add_u32 s14, s14, 2097152
  s_cmp_ge_u32 s2, 192
  s_cselect_b32 s12, s14, s12
  buffer_store_dwordx4 v[36:39], v20, s[56:59], s10 offen offset:0 sc1
  buffer_store_dwordx4 v[36:39], v20, s[56:59], s10 offen offset:1024 sc1
  buffer_store_dwordx4 v[36:39], v20, s[56:59], s10 offen offset:2048 sc1
  buffer_store_dwordx4 v[36:39], v20, s[56:59], s10 offen offset:3072 sc1
  buffer_store_dwordx4 v[36:39], v4, s[56:59], s11 offen sc1
  buffer_store_dwordx4 v[36:39], v20, s[56:59], s12 offen sc1
  s_barrier
  s_waitcnt vmcnt(0)
  ds_write_b32 v15, v13 offset:12
  s_branch L_qwait_215
L_nocl_216:
  s_barrier
  s_branch L_qwait_215
L_agg0_214:
  s_setprio 3
  s_lshl_b32 s10, s9, 11
  buffer_store_dwordx4 v[36:39], v20, s[56:59], s10 offen offset:0 sc1
  buffer_store_dwordx4 v[36:39], v20, s[56:59], s10 offen offset:1024 sc1
  s_lshl_b32 s10, s9, 2
  v_mov_b32 v14, s10
  s_barrier
  s_waitcnt vmcnt(0)
  s_mov_b64 exec, 1
  global_store_dword v14, v13, s[36:37] sc1
  s_mov_b64 exec, -1
  v_lshrrev_b32 v4, 5, v1
  v_lshlrev_b32 v4, 12, v4
  v_and_b32 v5, 31, v1
  v_lshl_add_u32 v4, v5, 4, v4
  s_lshl_b32 s10, s9, 9
  s_add_u32 s10, s10, 1933312
  s_add_u32 s72, s38, s10
  s_addc_u32 s73, s39, 0
  buffer_store_dwordx4 v[36:39], v4, s[56:59], s10 offen sc1
  s_add_u32 s10, s10, 8192
  buffer_store_dwordx4 v[36:39], v4, s[56:59], s10 offen sc1
  s_add_u32 s10, s10, 8192
  buffer_store_dwordx4 v[36:39], v4, s[56:59], s10 offen sc1
  s_add_u32 s10, s10, 8192
  buffer_store_dwordx4 v[36:39], v4, s[56:59], s10 offen sc1
  s_mov_b32 s10, 0
  s_mov_b32 s11, 0
  s_waitcnt vmcnt(0)
  s_mov_b32 s12, 0
L_probe_217:
  s_mov_b32 s61, 0
  s_load_dword s60, s[72:73], s12 offset:0
  s_load_dword s61, s[72:73], s12 offset:12288
  s_add_u32 s14, s10, 8
  s_waitcnt lgkmcnt(1)
L_prs_218:
  s_cmp_lg_u32 s61, 0
  s_cbranch_scc1 L_pro_219
  s_add_u32 s10, s10, 1
  s_cmp_lt_u32 s10, s14
  s_cbranch_scc1 L_prs_218
L_pro_219:
  s_waitcnt lgkmcnt(0)
  s_mov_b32 s61, 0
  s_load_dword s60, s[72:73], s12 offset:24576
  s_load_dword s61, s[72:73], s12 offset:4096
  s_add_u32 s14, s11, 8
  s_waitcnt lgkmcnt(1)
L_prs_220:
  s_cmp_lg_u32 s61, 0
  s_cbranch_scc1 L_pro_221
  s_add_u32 s11, s11, 1
  s_cmp_lt_u32 s11, s14
  s_cbranch_scc1 L_prs_220
L_pro_221:
  s_waitcnt lgkmcnt(0)
  s_mov_b32 s61, 0
  s_load_dword s60, s[72:73], s12 offset:16384
  s_load_dword s61, s[72:73], s12 offset:28672
  s_add_u32 s14, s10, 8
  s_waitcnt lgkmcnt(1)
L_prs_222:
  s_cmp_lg_u32 s61, 0
  s_cbranch_scc1 L_pro_223
  s_add_u32 s10, s10, 1
  s_cmp_lt_u32 s10, s14
  s_cbranch_scc1 L_prs_222
L_pro_223:
  s_waitcnt lgkmcnt(0)
  s_mov_b32 s61, 0
  s_load_dword s60, s[72:73], s12 offset:8192
  s_load_dword s61, s[72:73], s12 offset:20480
  s_add_u32 s14, s11, 8
  s_waitcnt lgkmcnt(1)
L_prs_224:
  s_cmp_lg_u32 s61, 0
  s_cbranch_scc1 L_pro_225
  s_add_u32 s11, s11, 1
  s_cmp_lt_u32 s11, s14
  s_cbranch_scc1 L_prs_224
L_pro_225:
  s_waitcnt lgkmcnt(0)
  s_add_u32 s12, s12, 128
  s_cmp_lt_u32 s12, 512
  s_cbranch_scc1 L_probe_217
  s_cmp_gt_u32 s11, s10
  s_cselect_b32 s12, 2, 1
  v_mov_b32 v4, s12
  s_mov_b64 exec, 1
  global_store_dword v14, v4, s[36:37] offset:32 sc1
  s_mov_b64 exec, -1
  s_setprio 0
L_qwait_215:
  s_mov_b32 s11, 0
L_wspin_226:
  ds_read_b32 v14, v15
  s_add_u32 s11, s11, 1
  s_cmp_ge_u32 s11, 262144
  s_waitcnt lgkmcnt(0)
  s_cbranch_scc1 L_aux_wo
  v_cmp_ne_u32 vcc, 0, v14
  s_cbranch_vccz L_wspin_226
L_aux_wo:
  s_setprio 0
  s_mov_b32 s44, s24
  s_and_b32 s45, s25, 0xffff
  s_mov_b32 s46, 4718592
  s_mov_b32 s47, 0x20000
  v_add_u32 v4, 0, v1
  v_mul_u32_u24 v5, 3641, v4
  v_lshrrev_b32 v5, 16, v5
  v_mul_u32_u24 v6, 18, v5
  v_sub_u32 v6, v4, v6
  v_mul_u32_u24 v5, 1152, v5
  v_lshl_add_u32 v40, v6, 4, v5
  v_add_u32 v4, 64, v1
  v_mul_u32_u24 v5, 3641, v4
  v_lshrrev_b32 v5, 16, v5
  v_mul_u32_u24 v6, 18, v5
  v_sub_u32 v6, v4, v6
  v_mul_u32_u24 v5, 1152, v5
  v_lshl_add_u32 v41, v6, 4, v5
  v_add_u32 v4, 128, v1
  v_mul_u32_u24 v5, 3641, v4
  v_lshrrev_b32 v5, 16, v5
  v_mul_u32_u24 v6, 18, v5
  v_sub_u32 v6, v4, v6
  v_mul_u32_u24 v5, 1152, v5
  v_lshl_add_u32 v42, v6, 4, v5
  v_add_u32 v4, 192, v1
  v_mul_u32_u24 v5, 3641, v4
  v_lshrrev_b32 v5, 16, v5
  v_mul_u32_u24 v6, 18, v5
  v_sub_u32 v6, v4, v6
  v_mul_u32_u24 v5, 1152, v5
  v_lshl_add_u32 v43, v6, 4, v5
  v_add_u32 v4, 256, v1
  v_mul_u32_u24 v5, 3641, v4
  v_lshrrev_b32 v5, 16, v5
  v_mul_u32_u24 v6, 18, v5
  v_sub_u32 v6, v4, v6
  v_mul_u32_u24 v5, 1152, v5
  v_lshl_add_u32 v44, v6, 4, v5
  v_add_u32 v4, 320, v1
  v_mul_u32_u24 v5, 3641, v4
  v_lshrrev_b32 v5, 16, v5
  v_mul_u32_u24 v6, 18, v5
  v_sub_u32 v6, v4, v6
  v_mul_u32_u24 v5, 1152, v5
  v_lshl_add_u32 v45, v6, 4, v5
  v_add_u32 v4, 384, v1
  v_mul_u32_u24 v5, 3641, v4
  v_lshrrev_b32 v5, 16, v5
  v_mul_u32_u24 v6, 18, v5
  v_sub_u32 v6, v4, v6
  v_mul_u32_u24 v5, 1152, v5
  v_lshl_add_u32 v46, v6, 4, v5
  v_add_u32 v4, 448, v1
  v_mul_u32_u24 v5, 3641, v4
  v_lshrrev_b32 v5, 16, v5
  v_mul_u32_u24 v6, 18, v5
  v_sub_u32 v6, v4, v6
  v_mul_u32_u24 v5, 1152, v5
  v_lshl_add_u32 v47, v6, 4, v5
  v_add_u32 v4, 512, v1
  v_mul_u32_u24 v5, 3641, v4
  v_lshrrev_b32 v5, 16, v5
  v_mul_u32_u24 v6, 18, v5
  v_sub_u32 v6, v4, v6
  v_mul_u32_u24 v5, 1152, v5
  v_lshl_add_u32 v48, v6, 4, v5
  s_mul_i32 s10, s4, 147456
  s_mul_i32 s11, s3, 288
  s_add_u32 s10, s10, s11
  s_mul_i32 s12, s3, 9216
  s_add_u32 s12, s12, 114688
  v_lshrrev_b32 v4, 2, v1
  v_and_b32 v4, 3, v4
  v_lshl_add_u32 v4, v10, 3, v4
  v_mul_u32_u24 v4, 288, v4
  v_and_b32 v5, 3, v1
  v_lshl_add_u32 v4, v5, 3, v4
  v_add_u32 v7, s12, v4
  s_add_u32 m0, s12, 0
  s_nop 0
  buffer_load_dwordx4 v40, s[44:47], s10 offen  lds
  s_add_u32 m0, s12, 1024
  s_nop 0
  buffer_load_dwordx4 v41, s[44:47], s10 offen  lds
  s_add_u32 m0, s12, 2048
  s_nop 0
  buffer_load_dwordx4 v42, s[44:47], s10 offen  lds
  s_add_u32 m0, s12, 3072
  s_waitcnt vmcnt(2)
  buffer_load_dwordx4 v43, s[44:47], s10 offen  lds
  s_add_u32 m0, s12, 4096
  s_waitcnt vmcnt(2)
  buffer_load_dwordx4 v44, s[44:47], s10 offen  lds
  s_add_u32 m0, s12, 5120
  s_waitcnt vmcnt(2)
  buffer_load_dwordx4 v45, s[44:47], s10 offen  lds
  s_add_u32 m0, s12, 6144
  s_waitcnt vmcnt(2)
  buffer_load_dwordx4 v46, s[44:47], s10 offen  lds
  s_add_u32 m0, s12, 7168
  s_waitcnt vmcnt(2)
  buffer_load_dwordx4 v47, s[44:47], s10 offen  lds
  s_add_u32 m0, s12, 8192
  s_waitcnt vmcnt(2)
  buffer_load_dwordx4 v48, s[44:47], s10 offen  lds
  s_waitcnt vmcnt(0)
  ds_read_b64_tr_b16 v[96:97], v7 offset:0
  ds_read_b64_tr_b16 v[98:99], v7 offset:1152
  ds_read_b64_tr_b16 v[100:101], v7 offset:32
  ds_read_b64_tr_b16 v[102:103], v7 offset:1184
  ds_read_b64_tr_b16 v[104:105], v7 offset:64
  ds_read_b64_tr_b16 v[106:107], v7 offset:1216
  ds_read_b64_tr_b16 v[108:109], v7 offset:96
  ds_read_b64_tr_b16 v[110:111], v7 offset:1248
  ds_read_b64_tr_b16 v[112:113], v7 offset:128
  ds_read_b64_tr_b16 v[114:115], v7 offset:1280
  ds_read_b64_tr_b16 v[116:117], v7 offset:160
  ds_read_b64_tr_b16 v[118:119], v7 offset:1312
  ds_read_b64_tr_b16 v[120:121], v7 offset:192
  ds_read_b64_tr_b16 v[122:123], v7 offset:1344
  ds_read_b64_tr_b16 v[124:125], v7 offset:224
  ds_read_b64_tr_b16 v[126:127], v7 offset:1376
  ds_read_b64_tr_b16 v[128:129], v7 offset:256
  ds_read_b64_tr_b16 v[130:131], v7 offset:1408
  s_cmp_lg_u32 s13, 1021
  s_cbranch_scc1 L_noag_227
  v_and_b32 v5, 7, v1
  v_lshlrev_b32 v5, 2, v5
  s_mov_b32 s11, 0
L_ag0spin_230:
  global_load_dword v14, v5, s[36:37] offset:32 sc1
  s_add_u32 s11, s11, 1
  s_cmp_ge_u32 s11, 16384
  s_waitcnt vmcnt(0)
  s_cbranch_scc1 L_agok_229
  v_cmp_eq_u32 vcc, 0, v14
  s_cbranch_vccnz L_ag0spin_230
  v_and_b32 v14, 2, v14
  v_cmp_ne_u32 vcc, 0, v14
  s_and_b32 s14, vcc_lo, 0xff
  s_bcnt1_i32_b32 s15, s14
  s_cmp_eq_u32 s15, 4
  s_cselect_b32 s14, s14, 0xf0
  v_mov_b32 v13, s14
  v_lshlrev_b32 v5, 6, v1
  s_mov_b32 s11, 0
  s_movk_i32 s15, 0x2000
L_agspin_228:
  buffer_load_dword v14, v5, s[56:59], 0 offen offset:0 sc1
  buffer_load_dword v16, v5, s[56:59], s15 offen offset:0 sc1
  v_add_u32 v5, 0x1000, v5
  buffer_load_dword v15, v5, s[56:59], 0 offen offset:0 sc1
  buffer_load_dword v17, v5, s[56:59], s15 offen offset:0 sc1
  v_lshlrev_b32 v5, 6, v1
  s_add_u32 s11, s11, 1
  s_cmp_ge_u32 s11, 16384
  s_waitcnt vmcnt(0)
  s_cbranch_scc1 L_agok_229
  v_or3_b32 v14, v14, v15, v16
  v_or_b32 v14, v14, v17
  v_cmp_ne_u32 vcc, 0, v14
  s_cbranch_vccnz L_agspin_228
L_agok_229:
  s_mov_b64 exec, 1
  global_store_dword v12, v13, s[36:37] offset:128 sc1
  s_mov_b64 exec, -1
L_noag_227:
  s_waitcnt lgkmcnt(0)
  s_add_u32 s10, s10, 36864
  s_add_u32 m0, s12, 0
  s_nop 0
  buffer_load_dwordx4 v40, s[44:47], s10 offen  lds
  s_add_u32 m0, s12, 1024
  s_nop 0
  buffer_load_dwordx4 v41, s[44:47], s10 offen  lds
  s_add_u32 m0, s12, 2048
  s_nop 0
  buffer_load_dwordx4 v42, s[44:47], s10 offen  lds
  s_add_u32 m0, s12, 3072
  s_waitcnt vmcnt(2)
  buffer_load_dwordx4 v43, s[44:47], s10 offen  lds
  s_add_u32 m0, s12, 4096
  s_waitcnt vmcnt(2)
  buffer_load_dwordx4 v44, s[44:47], s10 offen  lds
  s_add_u32 m0, s12, 5120
  s_waitcnt vmcnt(2)
  buffer_load_dwordx4 v45, s[44:47], s10 offen  lds
  s_add_u32 m0, s12, 6144
  s_waitcnt vmcnt(2)
  buffer_load_dwordx4 v46, s[44:47], s10 offen  lds
  s_add_u32 m0, s12, 7168
  s_waitcnt vmcnt(2)
  buffer_load_dwordx4 v47, s[44:47], s10 offen  lds
  s_add_u32 m0, s12, 8192
  s_waitcnt vmcnt(2)
  buffer_load_dwordx4 v48, s[44:47], s10 offen  lds
  s_waitcnt vmcnt(0)
  ds_read_b64_tr_b16 v[132:133], v7 offset:0
  ds_read_b64_tr_b16 v[134:135], v7 offset:1152
  ds_read_b64_tr_b16 v[136:137], v7 offset:32
  ds_read_b64_tr_b16 v[138:139], v7 offset:1184
  ds_read_b64_tr_b16 v[140:141], v7 offset:64
  ds_read_b64_tr_b16 v[142:143], v7 offset:1216
  ds_read_b64_tr_b16 v[144:145], v7 offset:96
  ds_read_b64_tr_b16 v[146:147], v7 offset:1248
  ds_read_b64_tr_b16 v[148:149], v7 offset:128
  ds_read_b64_tr_b16 v[150:151], v7 offset:1280
  ds_read_b64_tr_b16 v[152:153], v7 offset:160
  ds_read_b64_tr_b16 v[154:155], v7 offset:1312
  ds_read_b64_tr_b16 v[156:157], v7 offset:192
  ds_read_b64_tr_b16 v[158:159], v7 offset:1344
  ds_read_b64_tr_b16 v[160:161], v7 offset:224
  ds_read_b64_tr_b16 v[162:163], v7 offset:1376
  ds_read_b64_tr_b16 v[164:165], v7 offset:256
  ds_read_b64_tr_b16 v[166:167], v7 offset:1408
  s_waitcnt lgkmcnt(0)
  s_add_u32 s10, s10, 36864
  s_add_u32 m0, s12, 0
  s_nop 0
  buffer_load_dwordx4 v40, s[44:47], s10 offen  lds
  s_add_u32 m0, s12, 1024
  s_nop 0
  buffer_load_dwordx4 v41, s[44:47], s10 offen  lds
  s_add_u32 m0, s12, 2048
  s_nop 0
  buffer_load_dwordx4 v42, s[44:47], s10 offen  lds
  s_add_u32 m0, s12, 3072
  s_waitcnt vmcnt(2)
  buffer_load_dwordx4 v43, s[44:47], s10 offen  lds
  s_add_u32 m0, s12, 4096
  s_waitcnt vmcnt(2)
  buffer_load_dwordx4 v44, s[44:47], s10 offen  lds
  s_add_u32 m0, s12, 5120
  s_waitcnt vmcnt(2)
  buffer_load_dwordx4 v45, s[44:47], s10 offen  lds
  s_add_u32 m0, s12, 6144
  s_waitcnt vmcnt(2)
  buffer_load_dwordx4 v46, s[44:47], s10 offen  lds
  s_add_u32 m0, s12, 7168
  s_waitcnt vmcnt(2)
  buffer_load_dwordx4 v47, s[44:47], s10 offen  lds
  s_add_u32 m0, s12, 8192
  s_waitcnt vmcnt(2)
  buffer_load_dwordx4 v48, s[44:47], s10 offen  lds
  s_waitcnt vmcnt(0)
  ds_read_b64_tr_b16 v[168:169], v7 offset:0
  ds_read_b64_tr_b16 v[170:171], v7 offset:1152
  ds_read_b64_tr_b16 v[172:173], v7 offset:32
  ds_read_b64_tr_b16 v[174:175], v7 offset:1184
  ds_read_b64_tr_b16 v[176:177], v7 offset:64
  ds_read_b64_tr_b16 v[178:179], v7 offset:1216
  ds_read_b64_tr_b16 v[180:181], v7 offset:96
  ds_read_b64_tr_b16 v[182:183], v7 offset:1248
  ds_read_b64_tr_b16 v[184:185], v7 offset:128
  ds_read_b64_tr_b16 v[186:187], v7 offset:1280
  ds_read_b64_tr_b16 v[188:189], v7 offset:160
  ds_read_b64_tr_b16 v[190:191], v7 offset:1312
  ds_read_b64_tr_b16 v[192:193], v7 offset:192
  ds_read_b64_tr_b16 v[194:195], v7 offset:1344
  ds_read_b64_tr_b16 v[196:197], v7 offset:224
  ds_read_b64_tr_b16 v[198:199], v7 offset:1376
  ds_read_b64_tr_b16 v[200:201], v7 offset:256
  ds_read_b64_tr_b16 v[202:203], v7 offset:1408
  s_waitcnt lgkmcnt(0)
  s_add_u32 s10, s10, 36864
  s_add_u32 m0, s12, 0
  s_nop 0
  buffer_load_dwordx4 v40, s[44:47], s10 offen  lds
  s_add_u32 m0, s12, 1024
  s_nop 0
  buffer_load_dwordx4 v41, s[44:47], s10 offen  lds
  s_add_u32 m0, s12, 2048
  s_nop 0
  buffer_load_dwordx4 v42, s[44:47], s10 offen  lds
  s_add_u32 m0, s12, 3072
  s_waitcnt vmcnt(2)
  buffer_load_dwordx4 v43, s[44:47], s10 offen  lds
  s_add_u32 m0, s12, 4096
  s_waitcnt vmcnt(2)
  buffer_load_dwordx4 v44, s[44:47], s10 offen  lds
  s_add_u32 m0, s12, 5120
  s_waitcnt vmcnt(2)
  buffer_load_dwordx4 v45, s[44:47], s10 offen  lds
  s_add_u32 m0, s12, 6144
  s_waitcnt vmcnt(2)
  buffer_load_dwordx4 v46, s[44:47], s10 offen  lds
  s_add_u32 m0, s12, 7168
  s_waitcnt vmcnt(2)
  buffer_load_dwordx4 v47, s[44:47], s10 offen  lds
  s_add_u32 m0, s12, 8192
  s_waitcnt vmcnt(2)
  buffer_load_dwordx4 v48, s[44:47], s10 offen  lds
  s_waitcnt vmcnt(0)
  ds_read_b64_tr_b16 v[204:205], v7 offset:0
  ds_read_b64_tr_b16 v[206:207], v7 offset:1152
  ds_read_b64_tr_b16 v[208:209], v7 offset:32
  ds_read_b64_tr_b16 v[210:211], v7 offset:1184
  ds_read_b64_tr_b16 v[212:213], v7 offset:64
  ds_read_b64_tr_b16 v[214:215], v7 offset:1216
  ds_read_b64_tr_b16 v[216:217], v7 offset:96
  ds_read_b64_tr_b16 v[218:219], v7 offset:1248
  ds_read_b64_tr_b16 v[220:221], v7 offset:128
  ds_read_b64_tr_b16 v[222:223], v7 offset:1280
  ds_read_b64_tr_b16 v[224:225], v7 offset:160
  ds_read_b64_tr_b16 v[226:227], v7 offset:1312
  ds_read_b64_tr_b16 v[228:229], v7 offset:192
  ds_read_b64_tr_b16 v[230:231], v7 offset:1344
  ds_read_b64_tr_b16 v[232:233], v7 offset:224
  ds_read_b64_tr_b16 v[234:235], v7 offset:1376
  ds_read_b64_tr_b16 v[236:237], v7 offset:256
  ds_read_b64_tr_b16 v[238:239], v7 offset:1408
  s_waitcnt lgkmcnt(0)
  v_mov_b32 v19, 160768
  v_lshlrev_b32 v18, 22, v1
  s_and_b32 s62, s8, 7
  s_lshl_b32 s62, s62, 8
  s_add_u32 s62, s62, 133120
  s_mov_b32 s63, 0
  s_cmp_lg_u32 s3, 3
  s_cbranch_scc1 L_noac_231
L_acspin_232:
  ds_read_b32 v14, v19 offset:20
  s_add_u32 s63, s63, 1
  s_cmp_ge_u32 s63, 262144
  s_waitcnt lgkmcnt(0)
  s_cbranch_scc1 L_noac_231
  v_cmp_lt_u32 vcc, 3, v14
  s_cbranch_vccz L_acspin_232
  v_mov_b32 v14, 1
  buffer_atomic_add v14, v18, s[56:59], s62 offen sc0 sc1
  s_mov_b32 s100, 0x44220000
  s_mov_b32 s101, 0xfca88866
  s_add_u32 s62, s62, 2048
  s_waitcnt vmcnt(0)
  v_readfirstlane_b32 s15, v14
  s_add_u32 s15, s15, 1
  s_lshl_b32 s15, s15, 1
  s_and_b32 s15, s15, 0x3c
  s_lshr_b64 s[100:101], s[100:101], s15
  s_and_b32 s100, s100, 15
  v_mov_b32 v14, s100
  ds_write_b32 v19, v14 offset:24
L_acspin_233:
  ds_read_b32 v14, v19 offset:20
  s_add_u32 s63, s63, 1
  s_cmp_ge_u32 s63, 262144
  s_waitcnt lgkmcnt(0)
  s_cbranch_scc1 L_noac_231
  v_cmp_lt_u32 vcc, 7, v14
  s_cbranch_vccz L_acspin_233
  v_mov_b32 v14, 1
  buffer_atomic_add v14, v18, s[56:59], s62 offen sc0 sc1
  s_mov_b32 s100, 0x44220000
  s_mov_b32 s101, 0xfca88866
  s_add_u32 s62, s62, 2048
  s_waitcnt vmcnt(0)
  v_readfirstlane_b32 s15, v14
  s_add_u32 s15, s15, 1
  s_lshl_b32 s15, s15, 1
  s_and_b32 s15, s15, 0x3c
  s_lshr_b64 s[100:101], s[100:101], s15
  s_and_b32 s100, s100, 15
  v_mov_b32 v14, s100
  ds_write_b32 v19, v14 offset:24
L_acspin_234:
  ds_read_b32 v14, v19 offset:20
  s_add_u32 s63, s63, 1
  s_cmp_ge_u32 s63, 262144
  s_waitcnt lgkmcnt(0)
  s_cbranch_scc1 L_noac_231
  v_cmp_lt_u32 vcc, 11, v14
  s_cbranch_vccz L_acspin_234
  v_mov_b32 v14, 1
  buffer_atomic_add v14, v18, s[56:59], s62 offen sc0 sc1
  s_mov_b32 s100, 0x22000000
  s_mov_b32 s101, 0xfca88644
  s_add_u32 s62, s62, 2048
  s_waitcnt vmcnt(0)
  v_readfirstlane_b32 s15, v14
  s_add_u32 s15, s15, 1
  s_lshl_b32 s15, s15, 1
  s_and_b32 s15, s15, 0x3c
  s_lshr_b64 s[100:101], s[100:101], s15
  s_and_b32 s100, s100, 15
  v_mov_b32 v14, s100
  ds_write_b32 v19, v14 offset:24
L_noac_231:
  v_and_b32 v4, 3, v1
  v_lshlrev_b32 v4, 8, v4
  v_lshl_add_u32 v4, v10, 4, v4
  v_add_u32 v16, 153600, v4
  v_lshlrev_b32 v4, 4, v10
  v_mov_b32 v5, 1073741824
  v_cmp_eq_u32 vcc, 0, v11
  s_mul_i32 s12, s3, 18
  s_nop 0
  v_cndmask_b32 v17, v5, v4, vcc
  s_add_u32 s12, s12, s6
  s_lshl_b32 s12, s12, 7
  s_lshl_b32 s11, s4, 2
  s_add_u32 s12, s12, s11
  s_add_u32 s12, s12, s5
  s_lshl_b32 s12, s12, 6
  s_add_u32 s12, s12, 163840
  v_lshlrev_b32 v4, 14, v10
  v_lshl_add_u32 v17, v11, 2, v4
  v_lshlrev_b32 v4, 2, v11
  v_lshl_or_b32 v18, v10, 28, v4
  s_add_u32 s14, s12, 65536
  s_add_u32 s15, s12, 131072
  s_setprio 3
  s_barrier
  ds_read_b128 v[20:23], v16 offset:0
  ds_read_b128 v[24:27], v16 offset:64
  ds_read_b128 v[28:31], v16 offset:128
  ds_read_b128 v[32:35], v16 offset:192
  s_waitcnt lgkmcnt(3)
  v_mfma_f32_16x16x32_bf16 v[72:75], v[20:23], v[128:131], 0
  v_mfma_f32_16x16x32_bf16 v[40:43], v[20:23], v[96:99], 0
  v_mfma_f32_16x16x32_bf16 v[44:47], v[20:23], v[100:103], 0
  s_waitcnt lgkmcnt(2)
  v_mfma_f32_16x16x32_bf16 v[72:75], v[24:27], v[164:167], v[72:75]
  v_mfma_f32_16x16x32_bf16 v[40:43], v[24:27], v[132:135], v[40:43]
  v_mfma_f32_16x16x32_bf16 v[44:47], v[24:27], v[136:139], v[44:47]
  s_waitcnt lgkmcnt(1)
  v_mfma_f32_16x16x32_bf16 v[72:75], v[28:31], v[200:203], v[72:75]
  v_mfma_f32_16x16x32_bf16 v[40:43], v[28:31], v[168:171], v[40:43]
  v_mfma_f32_16x16x32_bf16 v[44:47], v[28:31], v[172:175], v[44:47]
  s_waitcnt lgkmcnt(0)
  v_mfma_f32_16x16x32_bf16 v[72:75], v[32:35], v[236:239], v[72:75]
  v_mfma_f32_16x16x32_bf16 v[40:43], v[32:35], v[204:207], v[40:43]
  v_mfma_f32_16x16x32_bf16 v[44:47], v[32:35], v[208:211], v[44:47]
  v_mfma_f32_16x16x32_bf16 v[48:51], v[20:23], v[104:107], 0
  v_mfma_f32_16x16x32_bf16 v[52:55], v[20:23], v[108:111], 0
  v_mfma_f32_16x16x32_bf16 v[48:51], v[24:27], v[140:143], v[48:51]
  v_mfma_f32_16x16x32_bf16 v[52:55], v[24:27], v[144:147], v[52:55]
  v_mfma_f32_16x16x32_bf16 v[48:51], v[28:31], v[176:179], v[48:51]
  v_mfma_f32_16x16x32_bf16 v[52:55], v[28:31], v[180:183], v[52:55]
  v_pk_add_f32 v[72:73], v[72:73], v[74:75]
  v_pk_add_f32 v[40:41], v[40:41], v[42:43]
  v_pk_add_f32 v[44:45], v[44:45], v[46:47]
  v_mfma_f32_16x16x32_bf16 v[48:51], v[32:35], v[212:215], v[48:51]
  v_mfma_f32_16x16x32_bf16 v[52:55], v[32:35], v[216:219], v[52:55]
  v_add_f32 v82, v72, v73
  buffer_store_dword v82, v18, s[56:59], s15 offen sc1
  v_add_f32 v80, v40, v41
  s_nop 1
  v_add_f32_dpp v80, v44, v45 quad_perm:[0,1,2,3] row_mask:0x2 bank_mask:0xf
  v_mfma_f32_16x16x32_bf16 v[56:59], v[20:23], v[112:115], 0
  v_mfma_f32_16x16x32_bf16 v[60:63], v[20:23], v[116:119], 0
  v_mfma_f32_16x16x32_bf16 v[56:59], v[24:27], v[148:151], v[56:59]
  v_mfma_f32_16x16x32_bf16 v[60:63], v[24:27], v[152:155], v[60:63]
  v_mfma_f32_16x16x32_bf16 v[56:59], v[28:31], v[184:187], v[56:59]
  v_mfma_f32_16x16x32_bf16 v[60:63], v[28:31], v[188:191], v[60:63]
  v_pk_add_f32 v[48:49], v[48:49], v[50:51]
  v_pk_add_f32 v[52:53], v[52:53], v[54:55]
  v_mfma_f32_16x16x32_bf16 v[56:59], v[32:35], v[220:223], v[56:59]
  v_mfma_f32_16x16x32_bf16 v[60:63], v[32:35], v[224:227], v[60:63]
  v_add_f32_dpp v80, v48, v49 quad_perm:[0,1,2,3] row_mask:0x4 bank_mask:0xf
  s_nop 1
  v_add_f32_dpp v80, v52, v53 quad_perm:[0,1,2,3] row_mask:0x8 bank_mask:0xf
  buffer_store_dword v80, v17, s[56:59], s12 offen sc1
  v_mfma_f32_16x16x32_bf16 v[64:67], v[20:23], v[120:123], 0
  v_mfma_f32_16x16x32_bf16 v[68:71], v[20:23], v[124:127], 0
  v_mfma_f32_16x16x32_bf16 v[64:67], v[24:27], v[156:159], v[64:67]
  v_mfma_f32_16x16x32_bf16 v[68:71], v[24:27], v[160:163], v[68:71]
  v_mfma_f32_16x16x32_bf16 v[64:67], v[28:31], v[192:195], v[64:67]
  v_mfma_f32_16x16x32_bf16 v[68:71], v[28:31], v[196:199], v[68:71]
  v_pk_add_f32 v[56:57], v[56:57], v[58:59]
  v_pk_add_f32 v[60:61], v[60:61], v[62:63]
  v_mfma_f32_16x16x32_bf16 v[64:67], v[32:35], v[228:231], v[64:67]
  v_mfma_f32_16x16x32_bf16 v[68:71], v[32:35], v[232:235], v[68:71]
  v_add_f32 v81, v56, v57
  s_nop 1
  v_add_f32_dpp v81, v60, v61 quad_perm:[0,1,2,3] row_mask:0x2 bank_mask:0xf
  s_nop 2
  v_pk_add_f32 v[64:65], v[64:65], v[66:67]
  v_pk_add_f32 v[68:69], v[68:69], v[70:71]
  s_nop 0
  v_add_f32_dpp v81, v64, v65 quad_perm:[0,1,2,3] row_mask:0x4 bank_mask:0xf
  s_nop 1
  v_add_f32_dpp v81, v68, v69 quad_perm:[0,1,2,3] row_mask:0x8 bank_mask:0xf
  buffer_store_dword v81, v17, s[56:59], s14 offen sc1
  s_endpgm
L_aux:
  s_sub_u32 s3, s3, 4
  v_lshlrev_b32 v20, 4, v1
  v_mov_b32 v36, -1
  v_mov_b32 v37, -1
  v_mov_b32 v38, -1
  v_mov_b32 v39, -1
  v_mov_b32 v12, 0
  v_mov_b32 v13, 1
  v_mov_b32 v15, 160768
  s_lshl_b32 s13, s2, 2
  s_add_u32 s13, s13, s3
  s_cmp_lg_u32 s3, 0
  s_cbranch_scc1 L_aux_other
  s_setprio 3
  s_lshl_b32 s15, s6, 2
  s_add_u32 s15, s15, s5
  v_lshrrev_b32 v4, 3, v11
  v_mul_u32_u24 v4, 1152, v4
  v_and_b32 v5, 7, v1
  v_lshl_add_u32 v5, v10, 3, v5
  v_mad_u32_u24 v2, v5, 36, v4
  v_mad_u32_u24 v3, v10, 36, v4
  v_mul_u32_u24 v6, 147456, v10
  v_lshl_add_u32 v6, v11, 4, v6
  s_mul_i32 s11, s15, 144
  s_mul_i32 s14, s15, 589824
  s_lshl_b32 s12, s4, 8
  s_add_u32 s14, s14, s12
  ds_write_b32 v15, v12
  ds_write_b32 v15, v12 offset:4
  ds_write_b32 v15, v12 offset:8
  ds_write_b32 v15, v12 offset:12
  ds_write_b32 v15, v12 offset:20
  v_mov_b32 v14, 8
  ds_write_b32 v15, v14 offset:24
  s_waitcnt lgkmcnt(0)
  s_mov_b32 s64, s16
  s_and_b32 s65, s17, 0xffff
  s_mov_b32 s66, 2304
  s_mov_b32 s67, 0x20000
  s_mov_b32 s40, s22
  s_and_b32 s41, s23, 0xffff
  s_mov_b32 s42, 4718592
  s_mov_b32 s43, 0x20000
  buffer_load_dwordx4 v[24:27], v2, s[64:67], 0 offen
  buffer_load_dwordx4 v[28:31], v2, s[64:67], 0 offen offset:16
  buffer_load_dword v32, v2, s[64:67], 0 offen offset:32
  buffer_load_dwordx4 v[40:43], v3, s[64:67], s11 offen
  buffer_load_dwordx4 v[44:47], v3, s[64:67], s11 offen offset:16
  buffer_load_dword v48, v3, s[64:67], s11 offen offset:32
  buffer_load_dwordx4 v[96:99], v6, s[40:43], s14 offen nt
  s_add_u32 s14, s14, 8192
  buffer_load_dwordx4 v[100:103], v6, s[40:43], s14 offen nt
  s_add_u32 s14, s14, 8192
  buffer_load_dwordx4 v[104:107], v6, s[40:43], s14 offen nt
  s_add_u32 s14, s14, 8192
  buffer_load_dwordx4 v[108:111], v6, s[40:43], s14 offen nt
  s_add_u32 s14, s14, 8192
  buffer_load_dwordx4 v[112:115], v6, s[40:43], s14 offen nt
  s_add_u32 s14, s14, 8192
  buffer_load_dwordx4 v[116:119], v6, s[40:43], s14 offen nt
  s_add_u32 s14, s14, 8192
  buffer_load_dwordx4 v[120:123], v6, s[40:43], s14 offen nt
  s_add_u32 s14, s14, 8192
  buffer_load_dwordx4 v[124:127], v6, s[40:43], s14 offen nt
  s_add_u32 s14, s14, 8192
  buffer_load_dwordx4 v[128:131], v6, s[40:43], s14 offen nt
  s_add_u32 s14, s14, 8192
  buffer_load_dwordx4 v[132:135], v6, s[40:43], s14 offen nt
  s_add_u32 s14, s14, 8192
  buffer_load_dwordx4 v[136:139], v6, s[40:43], s14 offen nt
  s_add_u32 s14, s14, 8192
  buffer_load_dwordx4 v[140:143], v6, s[40:43], s14 offen nt
  s_add_u32 s14, s14, 8192
  buffer_load_dwordx4 v[144:147], v6, s[40:43], s14 offen nt
  s_add_u32 s14, s14, 8192
  buffer_load_dwordx4 v[148:151], v6, s[40:43], s14 offen nt
  s_add_u32 s14, s14, 8192
  buffer_load_dwordx4 v[152:155], v6, s[40:43], s14 offen nt
  s_add_u32 s14, s14, 8192
  buffer_load_dwordx4 v[156:159], v6, s[40:43], s14 offen nt
  s_add_u32 s14, s14, 8192
  buffer_load_dwordx4 v[160:163], v6, s[40:43], s14 offen nt
  s_add_u32 s14, s14, 8192
  buffer_load_dwordx4 v[164:167], v6, s[40:43], s14 offen nt
  s_barrier
  s_mov_b32 s56, s38
  s_and_b32 s57, s39, 0xffff
  s_mov_b32 s58, 4194304
  s_mov_b32 s59, 0x20000
  v_and_b32 v4, 1, v11
  v_lshlrev_b32 v4, 4, v4
  v_mov_b32 v5, 0xffff
  v_lshlrev_b32 v4, v4, v5
  v_bfe_u32 v5, v11, 1, 2
  v_cmp_eq_u32 vcc, 0, v5
  s_nop 1
  v_cndmask_b32 v16, 0, v4, vcc
  v_cmp_eq_u32 vcc, 1, v5
  s_nop 1
  v_cndmask_b32 v17, 0, v4, vcc
  v_cmp_eq_u32 vcc, 2, v5
  s_nop 1
  v_cndmask_b32 v18, 0, v4, vcc
  v_cmp_eq_u32 vcc, 3, v5
  s_nop 1
  v_cndmask_b32 v19, 0, v4, vcc
  v_lshrrev_b32 v4, 1, v10
  v_lshlrev_b32 v4, 12, v4
  v_lshl_add_u32 v4, v11, 5, v4
  v_and_b32 v5, 1, v10
  v_lshl_add_u32 v21, v5, 4, v4
  s_and_b32 s10, s4, 7
  s_mul_i32 s10, s10, 36
  s_lshr_b32 s11, s4, 3
  s_add_u32 s10, s10, s11
  s_lshl_b32 s10, s10, 13
  s_add_u32 s10, s10, 2097152
  s_lshl_b32 s11, s15, 9
  s_add_u32 s11, s11, s10
  s_lshl_b32 s12, s6, 12
  s_add_u32 s12, s12, s10
  v_cmp_gt_u32 vcc, 16, v1
  v_mov_b32 v4, 1073741824
  v_lshlrev_b32 v5, 2, v1
  v_cndmask_b32 v22, v4, v5, vcc
  v_and_b32 v5, 7, v1
  v_lshlrev_b32 v23, 6, v5
  s_and_b32 s14, s4, 7
  s_lshl_b32 s10, s14, 2
  v_mov_b32 v9, s10
  s_lshl_b32 s14, s14, 2
  s_lshr_b32 s10, s4, 3
  s_add_u32 s14, s14, s10
  s_lshl_b32 s14, s14, 9
  s_lshl_b32 s15, s15, 6
  s_add_u32 s15, s15, s14
  s_waitcnt vmcnt(21)
  v_lshlrev_b32 v52, 16, v24
  v_and_b32 v53, 0xffff0000, v24
  v_lshlrev_b32 v54, 16, v25
  v_and_b32 v55, 0xffff0000, v25
  v_lshlrev_b32 v56, 16, v26
  v_and_b32 v57, 0xffff0000, v26
  v_lshlrev_b32 v58, 16, v27
  v_and_b32 v59, 0xffff0000, v27
  v_lshlrev_b32 v60, 16, v28
  v_and_b32 v61, 0xffff0000, v28
  v_lshlrev_b32 v62, 16, v29
  v_and_b32 v63, 0xffff0000, v29
  v_lshlrev_b32 v64, 16, v30
  v_and_b32 v65, 0xffff0000, v30
  v_lshlrev_b32 v66, 16, v31
  v_and_b32 v67, 0xffff0000, v31
  v_lshlrev_b32 v68, 16, v32
  v_and_b32 v69, 0xffff0000, v32
  v_add_f32 v4, v52, v53
  v_add_f32 v5, v54, v55
  v_add_f32 v4, v4, v56
  v_add_f32 v5, v5, v57
  v_add_f32 v4, v4, v58
  v_add_f32 v5, v5, v59
  v_add_f32 v4, v4, v60
  v_add_f32 v5, v5, v61
  v_add_f32 v4, v4, v62
  v_add_f32 v5, v5, v63
  v_add_f32 v4, v4, v64
  v_add_f32 v5, v5, v65
  v_add_f32 v4, v4, v66
  v_add_f32 v5, v5, v67
  v_add_f32 v4, v4, v68
  v_add_f32 v5, v5, v69
  v_add_f32 v4, v4, v5
  s_nop 1
  v_add_f32_dpp v4, v4, v4 quad_perm:[1,0,3,2] row_mask:0xf bank_mask:0xf
  s_nop 1
  v_add_f32_dpp v4, v4, v4 quad_perm:[2,3,0,1] row_mask:0xf bank_mask:0xf
  s_nop 1
  v_add_f32_dpp v4, v4, v4 row_half_mirror row_mask:0xf bank_mask:0xf
  v_mov_b32 v5, v4
  s_nop 1
  v_permlane32_swap_b32 v4, v5
  v_add_f32 v4, v4, v5
  v_mov_b32 v5, v4
  s_nop 1
  v_permlane16_swap_b32 v4, v5
  v_add_f32 v4, v4, v5
  v_mul_f32 v4, 0x3ae38e39, v4
  v_sub_f32 v52, v52, v4
  v_sub_f32 v53, v53, v4
  v_sub_f32 v54, v54, v4
  v_sub_f32 v55, v55, v4
  v_sub_f32 v56, v56, v4
  v_sub_f32 v57, v57, v4
  v_sub_f32 v58, v58, v4
  v_sub_f32 v59, v59, v4
  v_sub_f32 v60, v60, v4
  v_sub_f32 v61, v61, v4
  v_sub_f32 v62, v62, v4
  v_sub_f32 v63, v63, v4
  v_sub_f32 v64, v64, v4
  v_sub_f32 v65, v65, v4
  v_sub_f32 v66, v66, v4
  v_sub_f32 v67, v67, v4
  v_sub_f32 v68, v68, v4
  v_sub_f32 v69, v69, v4
  v_mul_f32 v5, v52, v52
  v_mul_f32 v6, v53, v53
  v_fmac_f32 v5, v54, v54
  v_fmac_f32 v6, v55, v55
  v_fmac_f32 v5, v56, v56
  v_fmac_f32 v6, v57, v57
  v_fmac_f32 v5, v58, v58
  v_fmac_f32 v6, v59, v59
  v_fmac_f32 v5, v60, v60
  v_fmac_f32 v6, v61, v61
  v_fmac_f32 v5, v62, v62
  v_fmac_f32 v6, v63, v63
  v_fmac_f32 v5, v64, v64
  v_fmac_f32 v6, v65, v65
  v_fmac_f32 v5, v66, v66
  v_fmac_f32 v6, v67, v67
  v_fmac_f32 v5, v68, v68
  v_fmac_f32 v6, v69, v69
  v_add_f32 v5, v5, v6
  s_nop 1
  v_add_f32_dpp v5, v5, v5 quad_perm:[1,0,3,2] row_mask:0xf bank_mask:0xf
  s_nop 1
  v_add_f32_dpp v5, v5, v5 quad_perm:[2,3,0,1] row_mask:0xf bank_mask:0xf
  s_nop 1
  v_add_f32_dpp v5, v5, v5 row_half_mirror row_mask:0xf bank_mask:0xf
  v_mov_b32 v6, v5
  s_nop 1
  v_permlane32_swap_b32 v5, v6
  v_add_f32 v5, v5, v6
  v_mov_b32 v6, v5
  s_nop 1
  v_permlane16_swap_b32 v5, v6
  v_add_f32 v5, v5, v6
  v_mul_f32 v8, 0x3ae38e39, v5
  v_cvt_pk_bf16_f32 v8, v8, v8
  v_and_b32 v8, 0xffff0000, v8
  v_add_f32 v8, 0x3727c5ac, v8
  v_cvt_pk_bf16_f32 v8, v8, v8
  v_and_b32 v8, 0xffff0000, v8
  v_sqrt_f32 v8, v8
  v_cvt_pk_bf16_f32 v6, v4, v4
  v_and_b32 v6, 0xffff0000, v6
  v_cvt_pk_bf16_f32 v8, v8, v8
  v_and_b32 v8, 0xffff0000, v8
  v_rcp_f32 v7, v8
  s_waitcnt vmcnt(18)
  v_lshlrev_b32 v52, 16, v40
  v_and_b32 v53, 0xffff0000, v40
  v_lshlrev_b32 v54, 16, v41
  v_and_b32 v55, 0xffff0000, v41
  v_lshlrev_b32 v56, 16, v42
  v_and_b32 v57, 0xffff0000, v42
  v_lshlrev_b32 v58, 16, v43
  v_and_b32 v59, 0xffff0000, v43
  v_lshlrev_b32 v60, 16, v44
  v_and_b32 v61, 0xffff0000, v44
  v_lshlrev_b32 v62, 16, v45
  v_and_b32 v63, 0xffff0000, v45
  v_lshlrev_b32 v64, 16, v46
  v_and_b32 v65, 0xffff0000, v46
  v_lshlrev_b32 v66, 16, v47
  v_and_b32 v67, 0xffff0000, v47
  v_lshlrev_b32 v68, 16, v48
  v_and_b32 v69, 0xffff0000, v48
  v_sub_f32 v52, v52, v6
  v_sub_f32 v53, v53, v6
  v_sub_f32 v54, v54, v6
  v_sub_f32 v55, v55, v6
  v_sub_f32 v56, v56, v6
  v_sub_f32 v57, v57, v6
  v_sub_f32 v58, v58, v6
  v_sub_f32 v59, v59, v6
  v_sub_f32 v60, v60, v6
  v_sub_f32 v61, v61, v6
  v_sub_f32 v62, v62, v6
  v_sub_f32 v63, v63, v6
  v_sub_f32 v64, v64, v6
  v_sub_f32 v65, v65, v6
  v_sub_f32 v66, v66, v6
  v_sub_f32 v67, v67, v6
  v_sub_f32 v68, v68, v6
  v_sub_f32 v69, v69, v6
  v_cvt_pk_bf16_f32 v40, v52, v53
  v_cvt_pk_bf16_f32 v41, v54, v55
  v_cvt_pk_bf16_f32 v42, v56, v57
  v_cvt_pk_bf16_f32 v43, v58, v59
  v_cvt_pk_bf16_f32 v44, v60, v61
  v_cvt_pk_bf16_f32 v45, v62, v63
  v_cvt_pk_bf16_f32 v46, v64, v65
  v_cvt_pk_bf16_f32 v47, v66, v67
  v_cvt_pk_bf16_f32 v48, v68, v69
  v_lshlrev_b32 v52, 16, v40
  v_and_b32 v53, 0xffff0000, v40
  v_lshlrev_b32 v54, 16, v41
  v_and_b32 v55, 0xffff0000, v41
  v_lshlrev_b32 v56, 16, v42
  v_and_b32 v57, 0xffff0000, v42
  v_lshlrev_b32 v58, 16, v43
  v_and_b32 v59, 0xffff0000, v43
  v_lshlrev_b32 v60, 16, v44
  v_and_b32 v61, 0xffff0000, v44
  v_lshlrev_b32 v62, 16, v45
  v_and_b32 v63, 0xffff0000, v45
  v_lshlrev_b32 v64, 16, v46
  v_and_b32 v65, 0xffff0000, v46
  v_lshlrev_b32 v66, 16, v47
  v_and_b32 v67, 0xffff0000, v47
  v_lshlrev_b32 v68, 16, v48
  v_and_b32 v69, 0xffff0000, v48
  v_mul_f32 v52, v52, v7
  v_mul_f32 v53, v53, v7
  v_mul_f32 v54, v54, v7
  v_mul_f32 v55, v55, v7
  v_mul_f32 v56, v56, v7
  v_mul_f32 v57, v57, v7
  v_mul_f32 v58, v58, v7
  v_mul_f32 v59, v59, v7
  v_mul_f32 v60, v60, v7
  v_mul_f32 v61, v61, v7
  v_mul_f32 v62, v62, v7
  v_mul_f32 v63, v63, v7
  v_mul_f32 v64, v64, v7
  v_mul_f32 v65, v65, v7
  v_mul_f32 v66, v66, v7
  v_mul_f32 v67, v67, v7
  v_mul_f32 v68, v68, v7
  v_mul_f32 v69, v69, v7
  v_cvt_pk_bf16_f32 v52, v52, v52
  v_cvt_pk_bf16_f32 v53, v53, v53
  v_cvt_pk_bf16_f32 v54, v54, v54
  v_cvt_pk_bf16_f32 v55, v55, v55
  v_cvt_pk_bf16_f32 v56, v56, v56
  v_cvt_pk_bf16_f32 v57, v57, v57
  v_cvt_pk_bf16_f32 v58, v58, v58
  v_cvt_pk_bf16_f32 v59, v59, v59
  v_cvt_pk_bf16_f32 v60, v60, v60
  v_cvt_pk_bf16_f32 v61, v61, v61
  v_cvt_pk_bf16_f32 v62, v62, v62
  v_cvt_pk_bf16_f32 v63, v63, v63
  v_cvt_pk_bf16_f32 v64, v64, v64
  v_cvt_pk_bf16_f32 v65, v65, v65
  v_cvt_pk_bf16_f32 v66, v66, v66
  v_cvt_pk_bf16_f32 v67, v67, v67
  v_cvt_pk_bf16_f32 v68, v68, v68
  v_cvt_pk_bf16_f32 v69, v69, v69
  v_and_b32 v24, v52, v16
  v_and_b32 v25, v52, v17
  v_and_b32 v26, v52, v18
  v_and_b32 v27, v52, v19
  s_waitcnt vmcnt(17)
  s_nop 0
  v_mfma_f32_16x16x32_bf16 v[40:43], v[24:27], v[96:99], 0
  v_and_b32 v28, v53, v16
  v_and_b32 v29, v53, v17
  v_and_b32 v30, v53, v18
  v_and_b32 v31, v53, v19
  s_waitcnt vmcnt(16)
  s_nop 0
  v_mfma_f32_16x16x32_bf16 v[44:47], v[28:31], v[100:103], 0
  v_and_b32 v32, v54, v16
  v_and_b32 v33, v54, v17
  v_and_b32 v34, v54, v18
  v_and_b32 v35, v54, v19
  s_waitcnt vmcnt(15)
  s_nop 0
  v_mfma_f32_16x16x32_bf16 v[40:43], v[32:35], v[104:107], v[40:43]
  v_and_b32 v24, v55, v16
  v_and_b32 v25, v55, v17
  v_and_b32 v26, v55, v18
  v_and_b32 v27, v55, v19
  s_waitcnt vmcnt(14)
  s_nop 0
  v_mfma_f32_16x16x32_bf16 v[44:47], v[24:27], v[108:111], v[44:47]
  v_and_b32 v28, v56, v16
  v_and_b32 v29, v56, v17
  v_and_b32 v30, v56, v18
  v_and_b32 v31, v56, v19
  s_waitcnt vmcnt(13)
  s_nop 0
  v_mfma_f32_16x16x32_bf16 v[40:43], v[28:31], v[112:115], v[40:43]
  v_and_b32 v32, v57, v16
  v_and_b32 v33, v57, v17
  v_and_b32 v34, v57, v18
  v_and_b32 v35, v57, v19
  s_waitcnt vmcnt(12)
  s_nop 0
  v_mfma_f32_16x16x32_bf16 v[44:47], v[32:35], v[116:119], v[44:47]
  v_and_b32 v24, v58, v16
  v_and_b32 v25, v58, v17
  v_and_b32 v26, v58, v18
  v_and_b32 v27, v58, v19
  s_waitcnt vmcnt(11)
  s_nop 0
  v_mfma_f32_16x16x32_bf16 v[40:43], v[24:27], v[120:123], v[40:43]
  v_and_b32 v28, v59, v16
  v_and_b32 v29, v59, v17
  v_and_b32 v30, v59, v18
  v_and_b32 v31, v59, v19
  s_waitcnt vmcnt(10)
  s_nop 0
  v_mfma_f32_16x16x32_bf16 v[44:47], v[28:31], v[124:127], v[44:47]
  v_and_b32 v32, v60, v16
  v_and_b32 v33, v60, v17
  v_and_b32 v34, v60, v18
  v_and_b32 v35, v60, v19
  s_waitcnt vmcnt(9)
  s_nop 0
  v_mfma_f32_16x16x32_bf16 v[40:43], v[32:35], v[128:131], v[40:43]
  v_and_b32 v24, v61, v16
  v_and_b32 v25, v61, v17
  v_and_b32 v26, v61, v18
  v_and_b32 v27, v61, v19
  s_waitcnt vmcnt(8)
  s_nop 0
  v_mfma_f32_16x16x32_bf16 v[44:47], v[24:27], v[132:135], v[44:47]
  v_and_b32 v28, v62, v16
  v_and_b32 v29, v62, v17
  v_and_b32 v30, v62, v18
  v_and_b32 v31, v62, v19
  s_waitcnt vmcnt(7)
  s_nop 0
  v_mfma_f32_16x16x32_bf16 v[40:43], v[28:31], v[136:139], v[40:43]
  v_and_b32 v32, v63, v16
  v_and_b32 v33, v63, v17
  v_and_b32 v34, v63, v18
  v_and_b32 v35, v63, v19
  s_waitcnt vmcnt(6)
  s_nop 0
  v_mfma_f32_16x16x32_bf16 v[44:47], v[32:35], v[140:143], v[44:47]
  v_and_b32 v24, v64, v16
  v_and_b32 v25, v64, v17
  v_and_b32 v26, v64, v18
  v_and_b32 v27, v64, v19
  s_waitcnt vmcnt(5)
  s_nop 0
  v_mfma_f32_16x16x32_bf16 v[40:43], v[24:27], v[144:147], v[40:43]
  v_and_b32 v28, v65, v16
  v_and_b32 v29, v65, v17
  v_and_b32 v30, v65, v18
  v_and_b32 v31, v65, v19
  s_waitcnt vmcnt(4)
  s_nop 0
  v_mfma_f32_16x16x32_bf16 v[44:47], v[28:31], v[148:151], v[44:47]
  v_and_b32 v32, v66, v16
  v_and_b32 v33, v66, v17
  v_and_b32 v34, v66, v18
  v_and_b32 v35, v66, v19
  s_waitcnt vmcnt(3)
  s_nop 0
  v_mfma_f32_16x16x32_bf16 v[40:43], v[32:35], v[152:155], v[40:43]
  v_and_b32 v24, v67, v16
  v_and_b32 v25, v67, v17
  v_and_b32 v26, v67, v18
  v_and_b32 v27, v67, v19
  s_waitcnt vmcnt(2)
  s_nop 0
  v_mfma_f32_16x16x32_bf16 v[44:47], v[24:27], v[156:159], v[44:47]
  v_and_b32 v28, v68, v16
  v_and_b32 v29, v68, v17
  v_and_b32 v30, v68, v18
  v_and_b32 v31, v68, v19
  s_waitcnt vmcnt(1)
  s_nop 0
  v_mfma_f32_16x16x32_bf16 v[40:43], v[28:31], v[160:163], v[40:43]
  v_and_b32 v32, v69, v16
  v_and_b32 v33, v69, v17
  v_and_b32 v34, v69, v18
  v_and_b32 v35, v69, v19
  s_waitcnt vmcnt(0)
  s_nop 0
  v_mfma_f32_16x16x32_bf16 v[44:47], v[32:35], v[164:167], v[44:47]
  global_load_dword v14, v9, s[36:37]
  s_nop 6
  v_add_f32 v40, v40, v44
  v_add_f32 v41, v41, v45
  v_add_f32 v42, v42, v46
  v_add_f32 v43, v43, v47
  buffer_store_dwordx4 v[40:43], v21, s[56:59], s11 offen sc1
  s_mov_b32 s11, 0
L_flspin_208:
  s_waitcnt vmcnt(0)
  v_cmp_ne_u32 vcc, 0, v14
  s_cbranch_vccnz L_flok_209
  global_load_dword v14, v9, s[36:37] sc1
  s_add_u32 s11, s11, 1
  s_cmp_lt_u32 s11, 16384
  s_cbranch_scc1 L_flspin_208
L_flok_209:
  s_mov_b32 s11, 0
L_clspin_210:
  ds_read_b32 v14, v15 offset:12
  s_add_u32 s11, s11, 1
  s_cmp_ge_u32 s11, 262144
  s_waitcnt lgkmcnt(0)
  s_cbranch_scc1 L_clok_211
  v_cmp_ne_u32 vcc, 0, v14
  s_cbranch_vccz L_clspin_210
L_clok_211:
  buffer_store_dword v12, v22, s[56:59], s15 offen offset:0 sc1
  s_mov_b32 s11, 0
  s_waitcnt vmcnt(0)
L_qfspin_212:
  buffer_load_dword v14, v23, s[56:59], s14 offen offset:0 sc1
  s_add_u32 s11, s11, 1
  s_cmp_ge_u32 s11, 16384
  s_waitcnt vmcnt(0)
  s_cbranch_scc1 L_qfok_213
  v_cmp_ne_u32 vcc, 0, v14
  s_cbranch_vccnz L_qfspin_212
L_qfok_213:
  buffer_load_dwordx4 v[96:99], v20, s[56:59], s12 offen offset:0
  buffer_load_dwordx4 v[100:103], v20, s[56:59], s12 offen offset:1024
  buffer_load_dwordx4 v[104:107], v20, s[56:59], s12 offen offset:2048
  buffer_load_dwordx4 v[108:111], v20, s[56:59], s12 offen offset:3072
  v_and_b32 v5, 31, v1
  v_lshlrev_b32 v5, 3, v5
  v_add_u32 v5, 151552, v5
  s_waitcnt vmcnt(2)
  v_add_f32 v96, v96, v100
  v_add_f32 v97, v97, v101
  v_add_f32 v98, v98, v102
  v_add_f32 v99, v99, v103
  s_waitcnt vmcnt(0)
  v_add_f32 v104, v104, v108
  v_add_f32 v105, v105, v109
  v_add_f32 v106, v106, v110
  v_add_f32 v107, v107, v111
  v_add_f32 v96, v96, v104
  v_add_f32 v97, v97, v105
  v_add_f32 v98, v98, v106
  v_add_f32 v99, v99, v107
  v_mov_b32 v100, v96
  v_mov_b32 v101, v97
  v_mov_b32 v102, v98
  v_mov_b32 v103, v99
  v_permlane32_swap_b32 v96, v100
  v_permlane32_swap_b32 v97, v101
  v_permlane32_swap_b32 v98, v102
  v_permlane32_swap_b32 v99, v103
  v_add_f32 v96, v96, v100
  v_add_f32 v97, v97, v101
  v_add_f32 v98, v98, v102
  v_add_f32 v99, v99, v103
  v_cvt_pk_bf16_f32 v96, v96, v97
  v_cvt_pk_bf16_f32 v97, v98, v99
  ds_write_b64 v5, v[96:97]
  ds_write_b32 v15, v13
  s_branch L_aux_wo
.p2align 8
L_red:
  s_mul_i32 s14, s70, 9
  s_add_u32 s14, s14, s8
  s_sub_u32 s14, s14, 23
  s_mul_i32 s15, s69, 36
  s_add_u32 s15, s15, s14
  s_mov_b32 s64, s16
  s_and_b32 s65, s17, 0xffff
  s_mov_b32 s66, 2304
  s_mov_b32 s67, 0x20000
  s_mov_b32 s60, s34
  s_and_b32 s61, s35, 0xffff
  s_mov_b32 s62, 2304
  s_mov_b32 s63, 0x20000
  s_mov_b32 s71, 0
  v_and_b32 v4, 3, v1
  v_lshlrev_b32 v4, 2, v4
  v_and_b32 v5, 1, v10
  v_lshl_add_u32 v4, v5, 1, v4
  v_lshrrev_b32 v5, 1, v10
  v_add_lshl_u32 v4, v4, v5, 1
  s_lshl_b32 s10, s15, 5
  v_add_u32 v6, s10, v4
  buffer_load_ushort v21, v6, s[64:67], 0 offen
  v_lshrrev_b32 v5, 2, v11
  v_lshl_or_b32 v22, v5, 28, v6
  v_and_b32 v7, 2, v5
  v_add_u32 v5, v5, v7
  v_lshl_add_u32 v23, v5, 13, v4
  s_lshl_b32 s10, s14, 7
  s_lshl_b32 s12, s69, 14
  s_add_u32 s10, s10, s12
  s_add_u32 s10, s10, 65536
  v_lshlrev_b32 v20, 4, v1
  s_lshl_b32 s12, s14, 1
  s_add_u32 s12, s12, s69
  s_lshl_b32 s12, s12, 13
  s_add_u32 s12, s12, 163840
  s_waitcnt vmcnt(0)
  v_lshlrev_b32 v21, 16, v21
L_red_dry:
  s_add_u32 s13, s12, 4096
  s_add_u32 s14, s12, 589824
  s_mov_b32 s11, 0
  buffer_load_dwordx4 v[96:99], v20, s[56:59], s12 offen offset:0 sc1
  buffer_load_dwordx4 v[100:103], v20, s[56:59], s12 offen offset:1024 sc1
  buffer_load_dwordx4 v[104:107], v20, s[56:59], s12 offen offset:2048 sc1
  buffer_load_dwordx4 v[108:111], v20, s[56:59], s12 offen offset:3072 sc1
  buffer_load_dwordx4 v[112:115], v20, s[56:59], s13 offen offset:0 sc1
  buffer_load_dwordx4 v[116:119], v20, s[56:59], s13 offen offset:1024 sc1
  buffer_load_dwordx4 v[120:123], v20, s[56:59], s13 offen offset:2048 sc1
  buffer_load_dwordx4 v[124:127], v20, s[56:59], s13 offen offset:3072 sc1
L_r1_poll:
  buffer_load_dwordx4 v[132:135], v20, s[56:59], s12 offen offset:0 sc1
  buffer_load_dwordx4 v[136:139], v20, s[56:59], s12 offen offset:1024 sc1
  buffer_load_dwordx4 v[140:143], v20, s[56:59], s12 offen offset:2048 sc1
  buffer_load_dwordx4 v[144:147], v20, s[56:59], s12 offen offset:3072 sc1
  buffer_load_dwordx4 v[148:151], v20, s[56:59], s13 offen offset:0 sc1
  buffer_load_dwordx4 v[152:155], v20, s[56:59], s13 offen offset:1024 sc1
  buffer_load_dwordx4 v[156:159], v20, s[56:59], s13 offen offset:2048 sc1
  buffer_load_dwordx4 v[160:163], v20, s[56:59], s13 offen offset:3072 sc1
  s_waitcnt vmcnt(14)
  v_pk_add_f32 v[24:25], v[96:97], v[100:101]
  v_pk_add_f32 v[26:27], v[98:99], v[102:103]
  s_waitcnt vmcnt(12)
  v_pk_add_f32 v[28:29], v[104:105], v[108:109]
  v_pk_add_f32 v[30:31], v[106:107], v[110:111]
  v_pk_add_f32 v[24:25], v[24:25], v[28:29]
  v_pk_add_f32 v[26:27], v[26:27], v[30:31]
  s_waitcnt vmcnt(10)
  v_pk_add_f32 v[28:29], v[112:113], v[116:117]
  v_pk_add_f32 v[30:31], v[114:115], v[118:119]
  v_pk_add_f32 v[24:25], v[24:25], v[28:29]
  v_pk_add_f32 v[26:27], v[26:27], v[30:31]
  s_waitcnt vmcnt(8)
  v_pk_add_f32 v[28:29], v[120:121], v[124:125]
  v_pk_add_f32 v[30:31], v[122:123], v[126:127]
  v_pk_add_f32 v[24:25], v[24:25], v[28:29]
  v_pk_add_f32 v[26:27], v[26:27], v[30:31]
  s_nop 0
  v_permlane32_swap_b32 v24, v25
  v_permlane32_swap_b32 v26, v27
  v_add_f32 v24, v24, v25
  v_add_f32 v26, v26, v27
  s_nop 1
  v_permlane16_swap_b32 v24, v26
  v_add_f32 v4, v24, v26
  s_nop 1
  v_add_f32_dpp v4, v4, v4 row_ror:4 row_mask:0xf bank_mask:0xf
  s_nop 1
  v_add_f32_dpp v4, v4, v4 row_ror:8 row_mask:0xf bank_mask:0xf
  v_cmp_u_f32 vcc, v4, v4
  v_cvt_pk_bf16_f32 v4, v4, v4
  v_and_b32 v4, 0xffff0000, v4
  v_add_f32 v4, v4, v21
  v_cvt_pk_bf16_f32 v4, v4, v4
  s_cbranch_vccz L_r1_ok
  buffer_load_dwordx4 v[96:99], v20, s[56:59], s12 offen offset:0 sc1
  buffer_load_dwordx4 v[100:103], v20, s[56:59], s12 offen offset:1024 sc1
  buffer_load_dwordx4 v[104:107], v20, s[56:59], s12 offen offset:2048 sc1
  buffer_load_dwordx4 v[108:111], v20, s[56:59], s12 offen offset:3072 sc1
  buffer_load_dwordx4 v[112:115], v20, s[56:59], s13 offen offset:0 sc1
  buffer_load_dwordx4 v[116:119], v20, s[56:59], s13 offen offset:1024 sc1
  buffer_load_dwordx4 v[120:123], v20, s[56:59], s13 offen offset:2048 sc1
  buffer_load_dwordx4 v[124:127], v20, s[56:59], s13 offen offset:3072 sc1
  s_add_u32 s11, s11, 1
  s_cmp_lt_u32 s11, 16384
  s_waitcnt vmcnt(14)
  v_pk_add_f32 v[24:25], v[132:133], v[136:137]
  v_pk_add_f32 v[26:27], v[134:135], v[138:139]
  s_waitcnt vmcnt(12)
  v_pk_add_f32 v[28:29], v[140:141], v[144:145]
  v_pk_add_f32 v[30:31], v[142:143], v[146:147]
  v_pk_add_f32 v[24:25], v[24:25], v[28:29]
  v_pk_add_f32 v[26:27], v[26:27], v[30:31]
  s_waitcnt vmcnt(10)
  v_pk_add_f32 v[28:29], v[148:149], v[152:153]
  v_pk_add_f32 v[30:31], v[150:151], v[154:155]
  v_pk_add_f32 v[24:25], v[24:25], v[28:29]
  v_pk_add_f32 v[26:27], v[26:27], v[30:31]
  s_waitcnt vmcnt(8)
  v_pk_add_f32 v[28:29], v[156:157], v[160:161]
  v_pk_add_f32 v[30:31], v[158:159], v[162:163]
  v_pk_add_f32 v[24:25], v[24:25], v[28:29]
  v_pk_add_f32 v[26:27], v[26:27], v[30:31]
  s_nop 0
  v_permlane32_swap_b32 v24, v25
  v_permlane32_swap_b32 v26, v27
  v_add_f32 v24, v24, v25
  v_add_f32 v26, v26, v27
  s_nop 1
  v_permlane16_swap_b32 v24, v26
  v_add_f32 v4, v24, v26
  s_nop 1
  v_add_f32_dpp v4, v4, v4 row_ror:4 row_mask:0xf bank_mask:0xf
  s_nop 1
  v_add_f32_dpp v4, v4, v4 row_ror:8 row_mask:0xf bank_mask:0xf
  v_cmp_u_f32 vcc, v4, v4
  v_cvt_pk_bf16_f32 v4, v4, v4
  v_and_b32 v4, 0xffff0000, v4
  v_add_f32 v4, v4, v21
  v_cvt_pk_bf16_f32 v4, v4, v4
  s_cbranch_vccz L_r1_ok
  s_cbranch_scc1 L_r1_poll
L_r1_ok:
  buffer_store_short v4, v23, s[56:59], s10 offen sc1
  v_and_b32 v21, 0xffff0000, v4
  s_add_u32 s12, s12, 589824
  v_mul_u32_u24 v24, 1152, v1
  s_mov_b32 s11, 0
  s_mov_b64 exec, 255
L_can:
  buffer_load_dword v25, v24, s[56:59], s12 offen sc1
  s_add_u32 s11, s11, 1
  s_cmp_ge_u32 s11, 16384
  s_waitcnt vmcnt(0)
  s_cbranch_scc1 L_canok
  v_cmp_o_f32 vcc, v25, v25
  s_cbranch_vccz L_can
L_canok:
  s_mov_b64 exec, -1
  s_add_u32 s13, s12, 4096
  s_add_u32 s14, s12, 589824
  s_mov_b32 s11, 0
L_r3_poll:
  buffer_load_dwordx4 v[96:99], v20, s[56:59], s12 offen offset:0 sc1
  buffer_load_dwordx4 v[100:103], v20, s[56:59], s12 offen offset:1024 sc1
  buffer_load_dwordx4 v[104:107], v20, s[56:59], s12 offen offset:2048 sc1
  buffer_load_dwordx4 v[108:111], v20, s[56:59], s12 offen offset:3072 sc1
  buffer_load_dwordx4 v[112:115], v20, s[56:59], s13 offen offset:0 sc1
  buffer_load_dwordx4 v[116:119], v20, s[56:59], s13 offen offset:1024 sc1
  buffer_load_dwordx4 v[120:123], v20, s[56:59], s13 offen offset:2048 sc1
  buffer_load_dwordx4 v[124:127], v20, s[56:59], s13 offen offset:3072 sc1
  buffer_load_dwordx4 v[128:131], v20, s[56:59], s14 offen offset:0 sc1
  s_add_u32 s11, s11, 1
  s_cmp_lt_u32 s11, 16384
  s_waitcnt vmcnt(6)
  v_pk_add_f32 v[24:25], v[96:97], v[100:101]
  v_pk_add_f32 v[26:27], v[98:99], v[102:103]
  v_pk_add_f32 v[24:25], v[24:25], v[104:105]
  v_pk_add_f32 v[26:27], v[26:27], v[106:107]
  s_waitcnt vmcnt(4)
  v_pk_add_f32 v[28:29], v[108:109], v[112:113]
  v_pk_add_f32 v[30:31], v[110:111], v[114:115]
  v_pk_add_f32 v[24:25], v[24:25], v[28:29]
  v_pk_add_f32 v[26:27], v[26:27], v[30:31]
  s_waitcnt vmcnt(2)
  v_pk_add_f32 v[28:29], v[116:117], v[120:121]
  v_pk_add_f32 v[30:31], v[118:119], v[122:123]
  v_pk_add_f32 v[24:25], v[24:25], v[28:29]
  v_pk_add_f32 v[26:27], v[26:27], v[30:31]
  s_waitcnt vmcnt(0)
  v_pk_add_f32 v[28:29], v[124:125], v[128:129]
  v_pk_add_f32 v[30:31], v[126:127], v[130:131]
  v_pk_add_f32 v[24:25], v[24:25], v[28:29]
  v_pk_add_f32 v[26:27], v[26:27], v[30:31]
  s_nop 0
  v_permlane32_swap_b32 v24, v25
  v_permlane32_swap_b32 v26, v27
  v_add_f32 v24, v24, v25
  v_add_f32 v26, v26, v27
  s_nop 1
  v_permlane16_swap_b32 v24, v26
  v_add_f32 v4, v24, v26
  s_nop 1
  v_add_f32_dpp v4, v4, v4 row_ror:4 row_mask:0xf bank_mask:0xf
  s_nop 1
  v_add_f32_dpp v4, v4, v4 row_ror:8 row_mask:0xf bank_mask:0xf
  v_cmp_u_f32 vcc, v4, v4
  v_cvt_pk_bf16_f32 v4, v4, v4
  v_and_b32 v4, 0xffff0000, v4
  v_add_f32 v4, v4, v21
  v_cvt_pk_bf16_f32 v4, v4, v4
  s_cbranch_vccz L_r3_ok
  s_cbranch_scc1 L_r3_poll
L_r3_ok:
  buffer_store_short v4, v22, s[60:63], 0 offen
  s_endpgm
L_end:
  s_endpgm
.section .rodata,"a"
.p2align 6
.amdhsa_kernel sequential_preLN__mha_block_cached__glu_gated_geglu__decode_kernel
  .amdhsa_next_free_vgpr 256
  .amdhsa_next_free_sgpr 102
  .amdhsa_accum_offset 256
  .amdhsa_group_segment_fixed_size 0
  .amdhsa_kernarg_size 96
  .amdhsa_user_sgpr_count 2
  .amdhsa_user_sgpr_kernarg_segment_ptr 1
  .amdhsa_system_sgpr_workgroup_id_x 1
.end_amdhsa_kernel
```
